```python
import torch

def _softmax(x, axis=-1):
    return torch.softmax(x, dim=axis)
def _gelu(x):
    return torch.nn.functional.gelu(x, approximate="tanh")
def _silu(x):
    return torch.nn.functional.silu(x)
def _sigmoid(x):
    return torch.sigmoid(x)
def _layernorm(x, axis=-1, eps=1e-5):
    m = x.mean(dim=axis, keepdim=True)
    v = x.var(dim=axis, keepdim=True, unbiased=False)
    return (x - m) / torch.sqrt(v + eps)
def _scatter_add(tgt, idx, src, axis=0):
    return tgt.clone().index_add_(axis, idx, src)
def _segment_sum(src, seg, n):
    out = torch.zeros((n,) + src.shape[1:], dtype=src.dtype)
    return out.index_add_(0, seg, src)
def _pad(x, pw):
    flat = tuple(v for pair in reversed(pw) for v in pair)
    return torch.nn.functional.pad(x, flat)

kernel_name = 'standalone__mixer_token_mlp__prompt'

def setup_inputs():

    _w = (lambda a: (lambda t: t.to(torch.bfloat16) if t.is_floating_point() else t)(torch.as_tensor(a)))
    B, S, D, F = 1, 2048, 640, 1536
    return {
        "x": _w((lambda *s: torch.randn(*s, dtype=torch.bfloat16) * 0.05)(B, S, D)),
        "w1": _w((lambda *s: torch.randn(*s, dtype=torch.bfloat16) * 0.2)(S, F) * (S ** -0.5)),
        "b1": _w((lambda *s: torch.randn(*s, dtype=torch.bfloat16) * 1.6)(F) * 0.02),
        "w2": _w((lambda *s: torch.randn(*s, dtype=torch.bfloat16) * 0.05)(F, S) * (F ** -0.5)),
        "b2": _w((lambda *s: torch.randn(*s, dtype=torch.bfloat16) * 0.05)(S) * 0.02),
    }

def reference(x, w1, b1, w2, b2):
    B, S, D = x.shape
    h = _layernorm(x, axis=-1)
    u = torch.einsum("bsd,sf->bdf", h, w1) + b1
    u = _gelu(u)
    y = torch.einsum("bdf,fs->bds", u, w2) + b2
    return (lambda x, *d: x.permute(*d))(y, 0, 2, 1)
```

```asm
; @launch grid=(256,1,1) block=(256,1,1) lds=163840
.amdgcn_target "amdgcn-amd-amdhsa--gfx950"
.text
.globl standalone__mixer_token_mlp__prompt_kernel
.p2align 8
.type standalone__mixer_token_mlp__prompt_kernel,@function
standalone__mixer_token_mlp__prompt_kernel:
    s_cmp_ge_u32 s2, 256
    s_cbranch_scc1 L_done
    s_load_dwordx16 s[32:47], s[0:1], 0
    s_cmp_ge_u32 s2, 16
    s_cbranch_scc1 L_nocp
    s_getpc_b64 s[4:5]
L_pc:
    v_lshlrev_b32 v1, 7, v0
    v_min_u32 v1, L_end - L_pc - 4, v1
    global_load_dword v164, v1, s[4:5]
L_nocp:
    v_lshrrev_b32 v46, 6, v0
    v_lshrrev_b32 v48, 5, v0
    v_readfirstlane_b32 s48, v46
    v_and_b32 v49, 31, v0
    v_and_b32 v0, 63, v0
    s_lshr_b32 s96, s2, 2
    s_and_b32 s97, s2, 3
    s_lshl_b32 s98, s96, 5
    s_lshl2_add_u32 s98, s97, s98
    v_and_b32 v50, 3, v48
    v_lshrrev_b32 v51, 2, v48
    v_lshl_add_u32 v50, v51, 4, v50
    v_add_u32 v50, s98, v50
    v_mul_u32_u24 v50, 1280, v50
    v_lshl_add_u32 v51, v49, 3, v50
    v_lshl_add_u32 v50, v49, 4, v50
    s_lshr_b32 s96, s2, 3
    s_cmp_lt_u32 s96, 30
    s_cselect_b32 s3, 1, 0
    s_min_u32 s97, s96, 29
    s_mul_i32 s50, s97, 26
    s_lshr_b32 s50, s50, 8
    s_mul_i32 s98, s50, 10
    s_sub_u32 s49, s97, s98
    s_lshr_b32 s101, s49, 0
    s_mul_i32 s101, s101, 13
    s_lshr_b32 s101, s101, 3
    s_and_b32 s101, s101, 15
    s_and_b32 s97, s2, 7
    s_xor_b32 s97, s97, 2
    s_lshl3_add_u32 s50, s50, s97
    s_mul_i32 s99, s48, 1572864
    s_lshl_b32 s98, s50, 7
    s_add_u32 s99, s99, s98
    s_add_u32 s100, s99, 1572864
    s_mul_i32 s55, s101, 98304
    s_add_u32 s55, s55, s99
    s_mul_i32 s54, s48, 40960
    v_lshrrev_b32 v160, 3, v0
    v_bfe_u32 v54, v0, 1, 2
    v_lshrrev_b32 v162, 4, v0
    v_xor_b32 v54, v54, v162
    v_lshlrev_b32 v54, 5, v54
    v_and_b32 v56, 1, v0
    v_lshl_add_u32 v161, v56, 4, v54
    v_mul_u32_u24 v1, 3072, v160
    v_add_u32 v1, v1, v161
    v_add_u32 v2, 23552, v1
    v_add_u32 v3, 47104, v1
    v_add_u32 v4, 70656, v1
    s_lshr_b32 s96, s2, 3
    s_and_b32 s51, s96, 7
    s_lshr_b32 s52, s96, 3
    s_and_b32 s96, s2, 7
    s_lshl2_add_u32 s52, s96, s52
    v_lshlrev_b32 v30, 2, v0
    v_lshlrev_b32 v31, 1, v0
    s_lshl_b32 s96, s50, 7
    s_lshl_b32 s97, s52, 7
    s_mov_b32 s63, 4849664
    s_mov_b32 s6, 2621440
    s_mov_b32 s7, 0x20000
    s_mov_b32 s26, 3072
    s_mov_b32 s27, 0x20000
    s_mov_b32 s30, 4096
    s_mov_b32 s31, 0x20000
    s_mov_b32 s10, 6291456
    s_mov_b32 s11, 0x20000
    s_mov_b32 s18, 4915200
    s_mov_b32 s19, 0x20000
    s_mov_b32 s14, 6291456
    s_mov_b32 s15, 0x20000
    s_mov_b32 s22, 2621440
    s_mov_b32 s23, 0x20000
    s_waitcnt lgkmcnt(0)
    s_mov_b32 s4, s32
    s_and_b32 s5, s33, 0xffff
    buffer_load_dwordx4 v[60:63], v50, s[4:7], 0 offen
    buffer_load_dwordx4 v[64:67], v50, s[4:7], 0 offen offset:512
    buffer_load_dwordx2 v[68:69], v51, s[4:7], 0 offen offset:1024
    s_mov_b32 s24, s36
    s_and_b32 s25, s37, 0xffff
    s_mov_b32 s28, s40
    s_and_b32 s29, s41, 0xffff
    buffer_load_dword v165, v30, s[24:27], s96 offen
    buffer_load_ushort v166, v31, s[28:31], s97 offen
    s_mov_b32 s8, s34
    s_and_b32 s9, s35, 0xffff
    s_mov_b32 s16, s46
    s_and_b32 s17, s47, 0xffff
    s_buffer_load_dword s0, s[16:19], s63
    s_add_u32 m0, s54, 4096
    s_nop 0
    buffer_load_dwordx4 v1, s[8:11], s55 offen offset:0 lds
    buffer_load_dwordx4 v2, s[8:11], s55 offen offset:1024 lds
    buffer_load_dwordx4 v3, s[8:11], s55 offen offset:2048 lds
    buffer_load_dwordx4 v4, s[8:11], s55 offen offset:3072 lds
    s_add_u32 s55, s55, 98304
    s_cmp_eq_u32 s55, s100
    s_cselect_b32 s55, s99, s55
    s_add_u32 m0, s54, 8192
    s_nop 0
    buffer_load_dwordx4 v1, s[8:11], s55 offen offset:0 lds
    buffer_load_dwordx4 v2, s[8:11], s55 offen offset:1024 lds
    v_and_b32 v56, 1, v48
    v_mul_u32_u24 v56, 1344, v56
    v_add_u32 v56, s54, v56
    v_and_b32 v54, 1, v46
    v_lshl_add_u32 v56, v54, 7, v56
    v_lshl_add_u32 v51, v49, 3, v56
    v_lshl_add_u32 v50, v49, 4, v56
    v_and_b32 v163, 15, v0
    v_bfe_u32 v54, v0, 3, 1
    v_bfe_u32 v56, v0, 2, 1
    v_mul_u32_u24 v56, 1344, v56
    v_mul_u32_u24 v54, 41088, v54
    v_and_b32 v58, 3, v0
    v_add_u32 v56, v56, v54
    v_lshl_add_u32 v56, v58, 3, v56
    v_lshl_add_u32 v56, v162, 5, v56
    v_lshl_add_u32 v52, v46, 7, v56
    v_add_u32 v55, 81920, v52
    v_lshlrev_b32 v53, 4, v163
    v_lshl_add_u32 v53, v162, 10, v53
    v_lshl_add_u32 v53, v46, 12, v53
    s_lshr_b32 s96, s2, 2
    s_mul_i32 s96, s96, 40960
    s_and_b32 s97, s2, 3
    s_lshl_b32 s97, s97, 8
    s_add_u32 s96, s96, s97
    s_add_u32 s97, s96, 16384
    s_add_u32 s98, s96, 32768
    v_lshrrev_b32 v54, 2, v0
    v_bfe_u32 v56, v0, 3, 2
    v_lshlrev_b32 v54, 7, v54
    v_lshl_add_u32 v54, v58, 3, v54
    v_add_u32 v54, s54, v54
    v_xor_b32 v59, 0, v56
    v_lshl_add_u32 v9, v59, 5, v54
    v_xor_b32 v59, 1, v56
    v_lshl_add_u32 v10, v59, 5, v54
    v_xor_b32 v59, 2, v56
    v_lshl_add_u32 v11, v59, 5, v54
    v_xor_b32 v59, 3, v56
    v_lshl_add_u32 v12, v59, 5, v54
    v_lshlrev_b32 v47, 4, v0
    s_lshl_b32 s53, s48, 8
    s_add_u32 s53, s53, s2
    s_lshl_b32 s53, s53, 3
    s_add_u32 s53, s53, 4718592
    s_mov_b32 s62, s53
    s_mov_b32 s12, s38
    s_and_b32 s13, s39, 0xffff
    s_mov_b32 s20, s42
    s_and_b32 s21, s43, 0xffff
    v_lshl_add_u32 v5, v160, 12, v161
    v_add_u32 v6, 31744, v5
    v_add_u32 v7, 63488, v5
    v_add_u32 v8, 95232, v5
    v_add_u32 v25, s54, v47
    s_xor_b32 s4, s48, 1
    s_mul_i32 s4, s4, 40960
    v_add_u32 v26, s4, v47
    s_xor_b32 s4, s48, 2
    s_mul_i32 s4, s4, 40960
    v_add_u32 v27, s4, v47
    s_xor_b32 s4, s48, 3
    s_mul_i32 s4, s4, 40960
    v_add_u32 v28, s4, v47
    v_lshl_add_u32 v29, v46, 10, v47
    v_add_u32 v45, 81920, v29
    s_mul_i32 s4, s48, 655360
    s_lshl_b32 s5, s49, 12
    s_add_u32 s4, s4, s5
    s_add_u32 s5, s4, 655360
    s_mul_i32 s32, s101, 40960
    s_add_u32 s32, s32, s4
    s_add_u32 s33, s32, 40960
    s_cmp_eq_u32 s33, s5
    s_cselect_b32 s33, s4, s33
    s_add_u32 s34, s33, 40960
    s_cmp_eq_u32 s34, s5
    s_cselect_b32 s34, s4, s34
    s_add_u32 s35, s34, 40960
    s_cmp_eq_u32 s35, s5
    s_cselect_b32 s35, s4, s35
    s_add_u32 s36, s35, 40960
    s_cmp_eq_u32 s36, s5
    s_cselect_b32 s36, s4, s36
    s_add_u32 s37, s36, 40960
    s_cmp_eq_u32 s37, s5
    s_cselect_b32 s37, s4, s37
    s_add_u32 s38, s37, 40960
    s_cmp_eq_u32 s38, s5
    s_cselect_b32 s38, s4, s38
    s_add_u32 s39, s38, 40960
    s_cmp_eq_u32 s39, s5
    s_cselect_b32 s39, s4, s39
    s_add_u32 s40, s39, 40960
    s_cmp_eq_u32 s40, s5
    s_cselect_b32 s40, s4, s40
    s_add_u32 s41, s40, 40960
    s_cmp_eq_u32 s41, s5
    s_cselect_b32 s41, s4, s41
    s_add_u32 s42, s41, 40960
    s_cmp_eq_u32 s42, s5
    s_cselect_b32 s42, s4, s42
    s_add_u32 s43, s42, 40960
    s_cmp_eq_u32 s43, s5
    s_cselect_b32 s43, s4, s43
    s_add_u32 s44, s43, 40960
    s_cmp_eq_u32 s44, s5
    s_cselect_b32 s44, s4, s44
    s_add_u32 s45, s44, 40960
    s_cmp_eq_u32 s45, s5
    s_cselect_b32 s45, s4, s45
    s_add_u32 s46, s45, 40960
    s_cmp_eq_u32 s46, s5
    s_cselect_b32 s46, s4, s46
    s_add_u32 s47, s46, 40960
    s_cmp_eq_u32 s47, s5
    s_cselect_b32 s47, s4, s47
    s_and_b32 s53, s50, 0
    s_xor_b32 s53, s53, s48
    s_xor_b32 s4, s53, 0
    s_lshl_b32 s4, s4, 10
    v_add_u32 v13, s4, v47
    s_xor_b32 s4, s53, 1
    s_lshl_b32 s4, s4, 10
    v_add_u32 v14, s4, v47
    s_xor_b32 s4, s53, 2
    s_lshl_b32 s4, s4, 10
    v_add_u32 v15, s4, v47
    s_xor_b32 s4, s53, 3
    s_lshl_b32 s4, s4, 10
    v_add_u32 v16, s4, v47
    s_and_b32 s4, s49, 3
    s_lshl2_add_u32 s4, s4, s48
    s_lshl_b32 s4, s4, 9
    s_add_u32 s4, s4, 4718592
    v_lshl_add_u32 v19, v0, 3, s4
    buffer_load_dwordx4 v3, s[8:11], s55 offen offset:2048 lds
    buffer_load_dwordx4 v4, s[8:11], s55 offen offset:3072 lds
    s_add_u32 s55, s55, 98304
    s_cmp_eq_u32 s55, s100
    s_cselect_b32 s55, s99, s55
    s_waitcnt vmcnt(10)
    v_lshlrev_b32 v70, 16, v60
    v_and_b32 v71, 0xffff0000, v60
    v_lshlrev_b32 v72, 16, v61
    v_and_b32 v73, 0xffff0000, v61
    v_lshlrev_b32 v74, 16, v62
    v_and_b32 v75, 0xffff0000, v62
    v_lshlrev_b32 v76, 16, v63
    v_and_b32 v77, 0xffff0000, v63
    v_lshlrev_b32 v78, 16, v64
    v_and_b32 v79, 0xffff0000, v64
    v_lshlrev_b32 v80, 16, v65
    v_and_b32 v81, 0xffff0000, v65
    v_lshlrev_b32 v82, 16, v66
    v_and_b32 v83, 0xffff0000, v66
    v_lshlrev_b32 v84, 16, v67
    v_and_b32 v85, 0xffff0000, v67
    v_lshlrev_b32 v86, 16, v68
    v_and_b32 v87, 0xffff0000, v68
    v_lshlrev_b32 v88, 16, v69
    v_and_b32 v89, 0xffff0000, v69
    v_pk_add_f32 v[60:61], v[70:71], v[72:73]
    v_pk_add_f32 v[62:63], v[74:75], v[76:77]
    v_pk_add_f32 v[60:61], v[60:61], v[78:79]
    v_pk_add_f32 v[62:63], v[62:63], v[80:81]
    v_pk_add_f32 v[60:61], v[60:61], v[82:83]
    v_pk_add_f32 v[62:63], v[62:63], v[84:85]
    v_pk_add_f32 v[60:61], v[60:61], v[86:87]
    v_pk_add_f32 v[62:63], v[62:63], v[88:89]
    v_pk_add_f32 v[60:61], v[60:61], v[62:63]
    v_add_f32 v60, v60, v61
    s_nop 1
    v_add_f32_dpp v60, v60, v60 quad_perm:[1,0,3,2] row_mask:0xf bank_mask:0xf
    s_nop 1
    v_add_f32_dpp v60, v60, v60 quad_perm:[2,3,0,1] row_mask:0xf bank_mask:0xf
    s_nop 1
    v_add_f32_dpp v60, v60, v60 row_half_mirror row_mask:0xf bank_mask:0xf
    s_nop 1
    v_add_f32_dpp v60, v60, v60 row_mirror row_mask:0xf bank_mask:0xf
    v_mov_b32 v61, v60
    s_nop 1
    v_permlane16_swap_b32 v61, v60
    s_nop 1
    v_add_f32 v60, v60, v61
    v_mul_f32 v60, 0xbacccccd, v60
    v_pk_add_f32 v[70:71], v[70:71], v[60:61] op_sel_hi:[1,0]
    v_pk_add_f32 v[72:73], v[72:73], v[60:61] op_sel_hi:[1,0]
    v_pk_add_f32 v[74:75], v[74:75], v[60:61] op_sel_hi:[1,0]
    v_pk_add_f32 v[76:77], v[76:77], v[60:61] op_sel_hi:[1,0]
    v_pk_add_f32 v[78:79], v[78:79], v[60:61] op_sel_hi:[1,0]
    v_pk_add_f32 v[80:81], v[80:81], v[60:61] op_sel_hi:[1,0]
    v_pk_add_f32 v[82:83], v[82:83], v[60:61] op_sel_hi:[1,0]
    v_pk_add_f32 v[84:85], v[84:85], v[60:61] op_sel_hi:[1,0]
    v_pk_add_f32 v[86:87], v[86:87], v[60:61] op_sel_hi:[1,0]
    v_pk_add_f32 v[88:89], v[88:89], v[60:61] op_sel_hi:[1,0]
    v_pk_mul_f32 v[62:63], v[70:71], v[70:71]
    v_pk_mul_f32 v[64:65], v[72:73], v[72:73]
    v_pk_fma_f32 v[62:63], v[74:75], v[74:75], v[62:63]
    v_pk_fma_f32 v[64:65], v[76:77], v[76:77], v[64:65]
    v_pk_fma_f32 v[62:63], v[78:79], v[78:79], v[62:63]
    v_pk_fma_f32 v[64:65], v[80:81], v[80:81], v[64:65]
    v_pk_fma_f32 v[62:63], v[82:83], v[82:83], v[62:63]
    v_pk_fma_f32 v[64:65], v[84:85], v[84:85], v[64:65]
    v_pk_fma_f32 v[62:63], v[86:87], v[86:87], v[62:63]
    v_pk_fma_f32 v[64:65], v[88:89], v[88:89], v[64:65]
    v_pk_add_f32 v[62:63], v[62:63], v[64:65]
    v_add_f32 v62, v62, v63
    s_nop 1
    v_add_f32_dpp v62, v62, v62 quad_perm:[1,0,3,2] row_mask:0xf bank_mask:0xf
    s_nop 1
    v_add_f32_dpp v62, v62, v62 quad_perm:[2,3,0,1] row_mask:0xf bank_mask:0xf
    s_nop 1
    v_add_f32_dpp v62, v62, v62 row_half_mirror row_mask:0xf bank_mask:0xf
    s_nop 1
    v_add_f32_dpp v62, v62, v62 row_mirror row_mask:0xf bank_mask:0xf
    v_mov_b32 v63, v62
    s_nop 1
    v_permlane16_swap_b32 v63, v62
    s_nop 1
    v_add_f32 v62, v62, v63
    v_mul_f32 v62, 0x3acccccd, v62
    v_cvt_pk_bf16_f32 v64, v60, v62
    v_lshlrev_b32 v66, 16, v64
    v_and_b32 v64, 0xffff0000, v64
    v_add_f32 v64, 0x3727c5ac, v64
    v_cvt_pk_bf16_f32 v64, v64, v64
    v_lshlrev_b32 v64, 16, v64
    v_sqrt_f32 v64, v64
    v_sub_f32 v66, v66, v60
    v_cvt_pk_bf16_f32 v64, v64, v64
    v_lshlrev_b32 v64, 16, v64
    v_rcp_f32 v64, v64
    s_nop 0
    v_mul_f32 v66, v66, v64
    v_pk_fma_f32 v[70:71], v[70:71], v[64:65], v[66:67] op_sel_hi:[1,0,0]
    v_pk_fma_f32 v[72:73], v[72:73], v[64:65], v[66:67] op_sel_hi:[1,0,0]
    v_pk_fma_f32 v[74:75], v[74:75], v[64:65], v[66:67] op_sel_hi:[1,0,0]
    v_pk_fma_f32 v[76:77], v[76:77], v[64:65], v[66:67] op_sel_hi:[1,0,0]
    v_pk_fma_f32 v[78:79], v[78:79], v[64:65], v[66:67] op_sel_hi:[1,0,0]
    v_pk_fma_f32 v[80:81], v[80:81], v[64:65], v[66:67] op_sel_hi:[1,0,0]
    v_pk_fma_f32 v[82:83], v[82:83], v[64:65], v[66:67] op_sel_hi:[1,0,0]
    v_pk_fma_f32 v[84:85], v[84:85], v[64:65], v[66:67] op_sel_hi:[1,0,0]
    v_pk_fma_f32 v[86:87], v[86:87], v[64:65], v[66:67] op_sel_hi:[1,0,0]
    v_pk_fma_f32 v[88:89], v[88:89], v[64:65], v[66:67] op_sel_hi:[1,0,0]
    v_cvt_pk_bf16_f32 v60, v70, v71
    v_cvt_pk_bf16_f32 v61, v72, v73
    v_cvt_pk_bf16_f32 v62, v74, v75
    v_cvt_pk_bf16_f32 v63, v76, v77
    v_cvt_pk_bf16_f32 v64, v78, v79
    v_cvt_pk_bf16_f32 v65, v80, v81
    v_cvt_pk_bf16_f32 v66, v82, v83
    v_cvt_pk_bf16_f32 v67, v84, v85
    v_cvt_pk_bf16_f32 v68, v86, v87
    v_cvt_pk_bf16_f32 v69, v88, v89
    ds_write_b128 v50, v[60:63]
    ds_write_b128 v50, v[64:67] offset:512
    ds_write_b64 v51, v[68:69] offset:1024
    s_waitcnt lgkmcnt(0)
    s_barrier
    ds_read_b64_tr_b16 v[60:61], v52
    ds_read_b64_tr_b16 v[62:63], v55
    ds_read_b64_tr_b16 v[64:65], v52 offset:512
    ds_read_b64_tr_b16 v[66:67], v55 offset:512
    s_mul_i32 s7, s0, 0x41c64e6d
    s_add_u32 s7, s7, 0x3039
    v_mov_b32 v20, s7
    s_cmp_ge_u32 s48, 2
    s_cbranch_scc1 L_ln_two
    ds_read_b64_tr_b16 v[68:69], v52 offset:1024
    ds_read_b64_tr_b16 v[70:71], v55 offset:1024
    s_waitcnt lgkmcnt(0)
    buffer_store_dwordx4 v[68:71], v53, s[16:19], s98 offen sc1
L_ln_two:
    s_waitcnt lgkmcnt(0)
    buffer_store_dwordx4 v[60:63], v53, s[16:19], s96 offen sc1
    buffer_store_dwordx4 v[64:67], v53, s[16:19], s97 offen sc1
    s_cmp_eq_u32 s3, 0
    s_cbranch_scc1 L_helper
    s_waitcnt vmcnt(8)
    s_add_u32 m0, s54, 12288
    s_nop 0
    buffer_load_dwordx4 v1, s[8:11], s55 offen offset:0 lds
    s_waitcnt vmcnt(8)
    buffer_load_dwordx4 v2, s[8:11], s55 offen offset:1024 lds
    s_waitcnt vmcnt(8)
    buffer_load_dwordx4 v3, s[8:11], s55 offen offset:2048 lds
    ds_read_b64_tr_b16 a[0:1], v9 offset:4096
    ds_read_b64_tr_b16 a[2:3], v9 offset:6144
    ds_read_b64_tr_b16 a[4:5], v10 offset:4096
    ds_read_b64_tr_b16 a[6:7], v10 offset:6144
    ds_read_b64_tr_b16 a[8:9], v11 offset:4096
    ds_read_b64_tr_b16 a[10:11], v11 offset:6144
    ds_read_b64_tr_b16 a[12:13], v12 offset:4096
    ds_read_b64_tr_b16 a[14:15], v12 offset:6144
    s_waitcnt vmcnt(8)
    buffer_load_dwordx4 v4, s[8:11], s55 offen offset:3072 lds
    s_add_u32 s55, s55, 98304
    s_cmp_eq_u32 s55, s100
    s_cselect_b32 s55, s99, s55
    s_waitcnt vmcnt(8)
    s_add_u32 m0, s54, 16384
    s_nop 0
    buffer_load_dwordx4 v1, s[8:11], s55 offen offset:0 lds
    s_waitcnt vmcnt(8)
    buffer_load_dwordx4 v2, s[8:11], s55 offen offset:1024 lds
    s_waitcnt vmcnt(8)
    buffer_load_dwordx4 v3, s[8:11], s55 offen offset:2048 lds
    s_waitcnt lgkmcnt(7)
    ds_read_b64_tr_b16 a[16:17], v9 offset:8192
    ds_read_b64_tr_b16 a[18:19], v9 offset:10240
    ds_read_b64_tr_b16 a[20:21], v10 offset:8192
    ds_read_b64_tr_b16 a[22:23], v10 offset:10240
    ds_read_b64_tr_b16 a[24:25], v11 offset:8192
    ds_read_b64_tr_b16 a[26:27], v11 offset:10240
    ds_read_b64_tr_b16 a[28:29], v12 offset:8192
    ds_read_b64_tr_b16 a[30:31], v12 offset:10240
    s_waitcnt vmcnt(8)
    buffer_load_dwordx4 v4, s[8:11], s55 offen offset:3072 lds
    s_add_u32 s55, s55, 98304
    s_cmp_eq_u32 s55, s100
    s_cselect_b32 s55, s99, s55
    s_waitcnt vmcnt(8)
    s_buffer_atomic_swap s7, s[16:19], s62
    s_add_u32 m0, s54, 20480
    s_nop 0
    buffer_load_dwordx4 v1, s[8:11], s55 offen offset:0 lds
    s_waitcnt lgkmcnt(3)
    v_lshlrev_b32 v30, 3, v162
    v_lshlrev_b32 v31, 2, v163
    ds_bpermute_b32 v32, v30, v165 offset:0
    ds_bpermute_b32 v33, v30, v165 offset:4
    ds_bpermute_b32 v34, v30, v165 offset:32
    ds_bpermute_b32 v35, v30, v165 offset:36
    ds_bpermute_b32 v36, v30, v165 offset:64
    ds_bpermute_b32 v37, v30, v165 offset:68
    ds_bpermute_b32 v38, v30, v165 offset:96
    ds_bpermute_b32 v39, v30, v165 offset:100
    ds_bpermute_b32 v40, v31, v166 offset:0
    ds_bpermute_b32 v41, v31, v166 offset:64
    ds_bpermute_b32 v42, v31, v166 offset:128
    ds_bpermute_b32 v43, v31, v166 offset:192
    buffer_load_dwordx4 v2, s[8:11], s55 offen offset:1024 lds
    s_waitcnt vmcnt(9)
    buffer_load_dwordx4 v3, s[8:11], s55 offen offset:2048 lds
    s_waitcnt vmcnt(9)
    buffer_load_dwordx4 v4, s[8:11], s55 offen offset:3072 lds
    s_add_u32 s55, s55, 98304
    s_cmp_eq_u32 s55, s100
    s_cselect_b32 s55, s99, s55
    s_waitcnt vmcnt(9)
    s_add_u32 m0, s54, 24576
    s_nop 0
    buffer_load_dwordx4 v1, s[8:11], s55 offen offset:0 lds
    s_waitcnt vmcnt(9)
    buffer_load_dwordx4 v2, s[8:11], s55 offen offset:1024 lds
    s_waitcnt lgkmcnt(7)
    ds_read_b64_tr_b16 a[32:33], v9 offset:12288
    ds_read_b64_tr_b16 a[34:35], v9 offset:14336
    ds_read_b64_tr_b16 a[36:37], v10 offset:12288
    ds_read_b64_tr_b16 a[38:39], v10 offset:14336
    ds_read_b64_tr_b16 a[40:41], v11 offset:12288
    ds_read_b64_tr_b16 a[42:43], v11 offset:14336
    ds_read_b64_tr_b16 a[44:45], v12 offset:12288
    ds_read_b64_tr_b16 a[46:47], v12 offset:14336
    s_waitcnt vmcnt(9)
    buffer_load_dwordx4 v3, s[8:11], s55 offen offset:2048 lds
    s_waitcnt vmcnt(9)
    buffer_load_dwordx4 v4, s[8:11], s55 offen offset:3072 lds
    s_add_u32 s55, s55, 98304
    s_cmp_eq_u32 s55, s100
    s_cselect_b32 s55, s99, s55
    s_waitcnt vmcnt(9)
    s_add_u32 m0, s54, 28672
    s_nop 0
    buffer_load_dwordx4 v1, s[8:11], s55 offen offset:0 lds
    s_waitcnt vmcnt(9)
    buffer_load_dwordx4 v2, s[8:11], s55 offen offset:1024 lds
    s_waitcnt lgkmcnt(7)
    ds_read_b64_tr_b16 a[48:49], v9 offset:16384
    ds_read_b64_tr_b16 a[50:51], v9 offset:18432
    ds_read_b64_tr_b16 a[52:53], v10 offset:16384
    ds_read_b64_tr_b16 a[54:55], v10 offset:18432
    ds_read_b64_tr_b16 a[56:57], v11 offset:16384
    ds_read_b64_tr_b16 a[58:59], v11 offset:18432
    ds_read_b64_tr_b16 a[60:61], v12 offset:16384
    ds_read_b64_tr_b16 a[62:63], v12 offset:18432
    s_waitcnt vmcnt(9)
    buffer_load_dwordx4 v3, s[8:11], s55 offen offset:2048 lds
    s_waitcnt vmcnt(9)
    buffer_load_dwordx4 v4, s[8:11], s55 offen offset:3072 lds
    s_add_u32 s55, s55, 98304
    s_cmp_eq_u32 s55, s100
    s_cselect_b32 s55, s99, s55
    s_waitcnt vmcnt(9)
    s_add_u32 m0, s54, 32768
    s_nop 0
    buffer_load_dwordx4 v1, s[8:11], s55 offen offset:0 lds
    s_waitcnt vmcnt(9)
    buffer_load_dwordx4 v2, s[8:11], s55 offen offset:1024 lds
    s_waitcnt lgkmcnt(7)
    ds_read_b64_tr_b16 a[64:65], v9 offset:20480
    ds_read_b64_tr_b16 a[66:67], v9 offset:22528
    ds_read_b64_tr_b16 a[68:69], v10 offset:20480
    ds_read_b64_tr_b16 a[70:71], v10 offset:22528
    ds_read_b64_tr_b16 a[72:73], v11 offset:20480
    ds_read_b64_tr_b16 a[74:75], v11 offset:22528
    ds_read_b64_tr_b16 a[76:77], v12 offset:20480
    ds_read_b64_tr_b16 a[78:79], v12 offset:22528
    s_waitcnt vmcnt(9)
    buffer_load_dwordx4 v3, s[8:11], s55 offen offset:2048 lds
    s_waitcnt vmcnt(9)
    buffer_load_dwordx4 v4, s[8:11], s55 offen offset:3072 lds
    s_add_u32 s55, s55, 98304
    s_cmp_eq_u32 s55, s100
    s_cselect_b32 s55, s99, s55
    s_waitcnt vmcnt(9)
    s_add_u32 m0, s54, 36864
    s_nop 0
    buffer_load_dwordx4 v1, s[8:11], s55 offen offset:0 lds
    s_waitcnt vmcnt(9)
    buffer_load_dwordx4 v2, s[8:11], s55 offen offset:1024 lds
    s_waitcnt lgkmcnt(7)
    ds_read_b64_tr_b16 a[80:81], v9 offset:24576
    ds_read_b64_tr_b16 a[82:83], v9 offset:26624
    ds_read_b64_tr_b16 a[84:85], v10 offset:24576
    ds_read_b64_tr_b16 a[86:87], v10 offset:26624
    ds_read_b64_tr_b16 a[88:89], v11 offset:24576
    ds_read_b64_tr_b16 a[90:91], v11 offset:26624
    ds_read_b64_tr_b16 a[92:93], v12 offset:24576
    ds_read_b64_tr_b16 a[94:95], v12 offset:26624
    s_waitcnt vmcnt(9)
    buffer_load_dwordx4 v3, s[8:11], s55 offen offset:2048 lds
    s_waitcnt vmcnt(9)
    buffer_load_dwordx4 v4, s[8:11], s55 offen offset:3072 lds
    s_add_u32 s55, s55, 98304
    s_cmp_eq_u32 s55, s100
    s_cselect_b32 s55, s99, s55
    s_waitcnt vmcnt(9)
    s_add_u32 m0, s54, 4096
    s_nop 0
    buffer_load_dwordx4 v1, s[8:11], s55 offen offset:0 lds
    s_waitcnt vmcnt(9)
    buffer_load_dwordx4 v2, s[8:11], s55 offen offset:1024 lds
    s_waitcnt lgkmcnt(7)
    ds_read_b64_tr_b16 a[96:97], v9 offset:28672
    ds_read_b64_tr_b16 a[98:99], v9 offset:30720
    ds_read_b64_tr_b16 a[100:101], v10 offset:28672
    ds_read_b64_tr_b16 a[102:103], v10 offset:30720
    ds_read_b64_tr_b16 a[104:105], v11 offset:28672
    ds_read_b64_tr_b16 a[106:107], v11 offset:30720
    ds_read_b64_tr_b16 a[108:109], v12 offset:28672
    ds_read_b64_tr_b16 a[110:111], v12 offset:30720
    s_waitcnt vmcnt(9)
    buffer_load_dwordx4 v3, s[8:11], s55 offen offset:2048 lds
    s_waitcnt vmcnt(9)
    buffer_load_dwordx4 v4, s[8:11], s55 offen offset:3072 lds
    s_add_u32 s55, s55, 98304
    s_cmp_eq_u32 s55, s100
    s_cselect_b32 s55, s99, s55
    s_waitcnt vmcnt(9)
    s_add_u32 m0, s54, 8192
    s_nop 0
    buffer_load_dwordx4 v1, s[8:11], s55 offen offset:0 lds
    s_waitcnt vmcnt(9)
    buffer_load_dwordx4 v2, s[8:11], s55 offen offset:1024 lds
    s_waitcnt lgkmcnt(7)
    ds_read_b64_tr_b16 a[112:113], v9 offset:32768
    ds_read_b64_tr_b16 a[114:115], v9 offset:34816
    ds_read_b64_tr_b16 a[116:117], v10 offset:32768
    ds_read_b64_tr_b16 a[118:119], v10 offset:34816
    ds_read_b64_tr_b16 a[120:121], v11 offset:32768
    ds_read_b64_tr_b16 a[122:123], v11 offset:34816
    ds_read_b64_tr_b16 a[124:125], v12 offset:32768
    ds_read_b64_tr_b16 a[126:127], v12 offset:34816
    s_waitcnt vmcnt(9)
    buffer_load_dwordx4 v3, s[8:11], s55 offen offset:2048 lds
    s_waitcnt vmcnt(9)
    buffer_load_dwordx4 v4, s[8:11], s55 offen offset:3072 lds
    s_add_u32 s55, s55, 98304
    s_cmp_eq_u32 s55, s100
    s_cselect_b32 s55, s99, s55
    s_waitcnt vmcnt(9)
    s_add_u32 m0, s54, 12288
    s_nop 0
    buffer_load_dwordx4 v1, s[8:11], s55 offen offset:0 lds
    s_waitcnt vmcnt(9)
    buffer_load_dwordx4 v2, s[8:11], s55 offen offset:1024 lds
    s_waitcnt lgkmcnt(7)
    ds_read_b64_tr_b16 a[128:129], v9 offset:36864
    ds_read_b64_tr_b16 a[130:131], v9 offset:38912
    ds_read_b64_tr_b16 a[132:133], v10 offset:36864
    ds_read_b64_tr_b16 a[134:135], v10 offset:38912
    ds_read_b64_tr_b16 a[136:137], v11 offset:36864
    ds_read_b64_tr_b16 a[138:139], v11 offset:38912
    ds_read_b64_tr_b16 a[140:141], v12 offset:36864
    ds_read_b64_tr_b16 a[142:143], v12 offset:38912
    s_waitcnt vmcnt(9)
    buffer_load_dwordx4 v3, s[8:11], s55 offen offset:2048 lds
    s_waitcnt vmcnt(9)
    buffer_load_dwordx4 v4, s[8:11], s55 offen offset:3072 lds
    s_add_u32 s55, s55, 98304
    s_cmp_eq_u32 s55, s100
    s_cselect_b32 s55, s99, s55
    s_waitcnt vmcnt(9)
    s_add_u32 m0, s54, 16384
    s_nop 0
    buffer_load_dwordx4 v1, s[8:11], s55 offen offset:0 lds
    s_waitcnt vmcnt(9)
    buffer_load_dwordx4 v2, s[8:11], s55 offen offset:1024 lds
    s_waitcnt lgkmcnt(7)
    ds_read_b64_tr_b16 a[144:145], v9 offset:4096
    ds_read_b64_tr_b16 a[146:147], v9 offset:6144
    ds_read_b64_tr_b16 a[148:149], v10 offset:4096
    ds_read_b64_tr_b16 a[150:151], v10 offset:6144
    ds_read_b64_tr_b16 a[152:153], v11 offset:4096
    ds_read_b64_tr_b16 a[154:155], v11 offset:6144
    ds_read_b64_tr_b16 a[156:157], v12 offset:4096
    ds_read_b64_tr_b16 a[158:159], v12 offset:6144
    s_waitcnt vmcnt(9)
    buffer_load_dwordx4 v3, s[8:11], s55 offen offset:2048 lds
    s_waitcnt vmcnt(9)
    buffer_load_dwordx4 v4, s[8:11], s55 offen offset:3072 lds
    s_add_u32 s55, s55, 98304
    s_cmp_eq_u32 s55, s100
    s_cselect_b32 s55, s99, s55
    s_waitcnt vmcnt(9)
    s_add_u32 m0, s54, 20480
    s_nop 0
    buffer_load_dwordx4 v1, s[8:11], s55 offen offset:0 lds
    s_waitcnt vmcnt(9)
    buffer_load_dwordx4 v2, s[8:11], s55 offen offset:1024 lds
    s_waitcnt lgkmcnt(7)
    ds_read_b64_tr_b16 a[160:161], v9 offset:8192
    ds_read_b64_tr_b16 a[162:163], v9 offset:10240
    ds_read_b64_tr_b16 a[164:165], v10 offset:8192
    ds_read_b64_tr_b16 a[166:167], v10 offset:10240
    ds_read_b64_tr_b16 a[168:169], v11 offset:8192
    ds_read_b64_tr_b16 a[170:171], v11 offset:10240
    ds_read_b64_tr_b16 a[172:173], v12 offset:8192
    ds_read_b64_tr_b16 a[174:175], v12 offset:10240
    s_waitcnt vmcnt(9)
    buffer_load_dword v18, v19, s[16:19], 0 offen sc1
    buffer_load_dwordx4 v3, s[8:11], s55 offen offset:2048 lds
    s_waitcnt vmcnt(10)
    buffer_load_dwordx4 v4, s[8:11], s55 offen offset:3072 lds
    s_add_u32 s55, s55, 98304
    s_cmp_eq_u32 s55, s100
    s_cselect_b32 s55, s99, s55
    s_waitcnt vmcnt(10)
    s_add_u32 m0, s54, 24576
    s_nop 0
    buffer_load_dwordx4 v1, s[8:11], s55 offen offset:0 lds
    s_waitcnt vmcnt(10)
    buffer_load_dwordx4 v2, s[8:11], s55 offen offset:1024 lds
    s_waitcnt lgkmcnt(7)
    ds_read_b64_tr_b16 a[176:177], v9 offset:12288
    ds_read_b64_tr_b16 a[178:179], v9 offset:14336
    ds_read_b64_tr_b16 a[180:181], v10 offset:12288
    ds_read_b64_tr_b16 a[182:183], v10 offset:14336
    ds_read_b64_tr_b16 a[184:185], v11 offset:12288
    ds_read_b64_tr_b16 a[186:187], v11 offset:14336
    ds_read_b64_tr_b16 a[188:189], v12 offset:12288
    ds_read_b64_tr_b16 a[190:191], v12 offset:14336
    s_waitcnt vmcnt(10)
    buffer_load_dwordx4 v3, s[8:11], s55 offen offset:2048 lds
    s_waitcnt vmcnt(10)
    buffer_load_dwordx4 v4, s[8:11], s55 offen offset:3072 lds
    s_add_u32 s55, s55, 98304
    s_cmp_eq_u32 s55, s100
    s_cselect_b32 s55, s99, s55
    s_waitcnt vmcnt(10)
    s_add_u32 m0, s54, 28672
    s_nop 0
    buffer_load_dwordx4 v1, s[8:11], s55 offen offset:0 lds
    s_waitcnt vmcnt(10)
    buffer_load_dwordx4 v2, s[8:11], s55 offen offset:1024 lds
    s_waitcnt lgkmcnt(7)
    ds_read_b64_tr_b16 a[192:193], v9 offset:16384
    ds_read_b64_tr_b16 a[194:195], v9 offset:18432
    ds_read_b64_tr_b16 a[196:197], v10 offset:16384
    ds_read_b64_tr_b16 a[198:199], v10 offset:18432
    ds_read_b64_tr_b16 a[200:201], v11 offset:16384
    ds_read_b64_tr_b16 a[202:203], v11 offset:18432
    ds_read_b64_tr_b16 a[204:205], v12 offset:16384
    ds_read_b64_tr_b16 a[206:207], v12 offset:18432
    s_waitcnt vmcnt(10)
    buffer_load_dwordx4 v3, s[8:11], s55 offen offset:2048 lds
    s_waitcnt vmcnt(10)
    buffer_load_dwordx4 v4, s[8:11], s55 offen offset:3072 lds
    s_add_u32 s55, s55, 98304
    s_cmp_eq_u32 s55, s100
    s_cselect_b32 s55, s99, s55
    v_lshlrev_b32 v176, 16, v32
    v_and_b32 v177, 0xffff0000, v32
    v_lshlrev_b32 v178, 16, v33
    v_and_b32 v179, 0xffff0000, v33
    v_lshlrev_b32 v180, 16, v34
    v_and_b32 v181, 0xffff0000, v34
    v_lshlrev_b32 v182, 16, v35
    v_and_b32 v183, 0xffff0000, v35
    v_lshlrev_b32 v184, 16, v36
    v_and_b32 v185, 0xffff0000, v36
    v_lshlrev_b32 v186, 16, v37
    v_and_b32 v187, 0xffff0000, v37
    v_lshlrev_b32 v188, 16, v38
    v_and_b32 v189, 0xffff0000, v38
    v_lshlrev_b32 v190, 16, v39
    v_and_b32 v191, 0xffff0000, v39
    s_waitcnt vmcnt(10)
    v_cmp_ne_u32 vcc, v18, v20
    s_cbranch_vccz L_p1_ok
    s_mov_b32 s6, 0
L_p1_spin:
    buffer_load_dword v18, v19, s[16:19], 0 offen sc1
    s_add_u32 s6, s6, 1
    s_cmp_ge_u32 s6, 131072
    s_waitcnt vmcnt(0)
    s_cbranch_scc1 L_p1_ok
    v_cmp_ne_u32 vcc, v18, v20
    s_cbranch_vccnz L_p1_spin
L_p1_ok:
    s_waitcnt vmcnt(9)
    buffer_load_dwordx4 v[48:51], v16, s[16:19], s32 offen sc1
    s_waitcnt vmcnt(9)
    buffer_load_dwordx4 v[52:55], v16, s[16:19], s33 offen sc1
    s_waitcnt lgkmcnt(7)
    ds_read_b64_tr_b16 a[208:209], v9 offset:20480
    ds_read_b64_tr_b16 a[210:211], v9 offset:22528
    ds_read_b64_tr_b16 a[212:213], v10 offset:20480
    ds_read_b64_tr_b16 a[214:215], v10 offset:22528
    ds_read_b64_tr_b16 a[216:217], v11 offset:20480
    ds_read_b64_tr_b16 a[218:219], v11 offset:22528
    ds_read_b64_tr_b16 a[220:221], v12 offset:20480
    ds_read_b64_tr_b16 a[222:223], v12 offset:22528
    s_waitcnt vmcnt(9)
    buffer_load_dwordx4 v[56:59], v16, s[16:19], s34 offen sc1
    s_waitcnt vmcnt(9)
    buffer_load_dwordx4 v[60:63], v16, s[16:19], s35 offen sc1
    s_waitcnt vmcnt(9)
    buffer_load_dwordx4 v[64:67], v16, s[16:19], s36 offen sc1
    s_waitcnt vmcnt(9)
    buffer_load_dwordx4 v[68:71], v16, s[16:19], s37 offen sc1
    s_waitcnt lgkmcnt(7)
    ds_read_b64_tr_b16 a[224:225], v9 offset:24576
    ds_read_b64_tr_b16 a[226:227], v9 offset:26624
    ds_read_b64_tr_b16 a[228:229], v10 offset:24576
    ds_read_b64_tr_b16 a[230:231], v10 offset:26624
    ds_read_b64_tr_b16 a[232:233], v11 offset:24576
    ds_read_b64_tr_b16 a[234:235], v11 offset:26624
    ds_read_b64_tr_b16 a[236:237], v12 offset:24576
    ds_read_b64_tr_b16 a[238:239], v12 offset:26624
    s_waitcnt vmcnt(9)
    buffer_load_dwordx4 v[72:75], v16, s[16:19], s38 offen sc1
    s_waitcnt vmcnt(9)
    buffer_load_dwordx4 v[76:79], v16, s[16:19], s39 offen sc1
    s_waitcnt vmcnt(9)
    buffer_load_dwordx4 v[80:83], v16, s[16:19], s40 offen sc1
    s_waitcnt vmcnt(9)
    s_waitcnt lgkmcnt(7)
    ds_read_b64_tr_b16 a[240:241], v9 offset:28672
    ds_read_b64_tr_b16 a[242:243], v9 offset:30720
    ds_read_b64_tr_b16 a[244:245], v10 offset:28672
    ds_read_b64_tr_b16 a[246:247], v10 offset:30720
    ds_read_b64_tr_b16 a[248:249], v11 offset:28672
    ds_read_b64_tr_b16 a[250:251], v11 offset:30720
    ds_read_b64_tr_b16 a[252:253], v12 offset:28672
    ds_read_b64_tr_b16 a[254:255], v12 offset:30720
    s_waitcnt lgkmcnt(0)
    s_waitcnt vmcnt(8)
    v_mfma_f32_16x16x32_bf16 v[176:179], a[0:3], v[48:51], v[176:179]
    buffer_load_dwordx4 v[84:87], v16, s[16:19], s41 offen sc1
    v_mfma_f32_16x16x32_bf16 v[180:183], a[4:7], v[48:51], v[180:183]
    v_mfma_f32_16x16x32_bf16 v[184:187], a[8:11], v[48:51], v[184:187]
    v_mfma_f32_16x16x32_bf16 v[188:191], a[12:15], v[48:51], v[188:191]
    s_waitcnt vmcnt(8)
    v_mfma_f32_16x16x32_bf16 v[176:179], a[16:19], v[52:55], v[176:179]
    buffer_load_dwordx4 v[48:51], v16, s[16:19], s42 offen sc1
    v_mfma_f32_16x16x32_bf16 v[180:183], a[20:23], v[52:55], v[180:183]
    v_mfma_f32_16x16x32_bf16 v[184:187], a[24:27], v[52:55], v[184:187]
    v_mfma_f32_16x16x32_bf16 v[188:191], a[28:31], v[52:55], v[188:191]
    s_waitcnt vmcnt(8)
    v_mfma_f32_16x16x32_bf16 v[176:179], a[32:35], v[56:59], v[176:179]
    buffer_load_dwordx4 v[52:55], v16, s[16:19], s43 offen sc1
    v_mfma_f32_16x16x32_bf16 v[180:183], a[36:39], v[56:59], v[180:183]
    s_lshr_b32 s61, s51, 0
    v_mfma_f32_16x16x32_bf16 v[184:187], a[40:43], v[56:59], v[184:187]
    s_mul_i32 s61, s61, 3
    v_mfma_f32_16x16x32_bf16 v[188:191], a[44:47], v[56:59], v[188:191]
    s_waitcnt vmcnt(8)
    v_mfma_f32_16x16x32_bf16 v[176:179], a[48:51], v[60:63], v[176:179]
    buffer_load_dwordx4 v[56:59], v16, s[16:19], s44 offen sc1
    v_mfma_f32_16x16x32_bf16 v[180:183], a[52:55], v[60:63], v[180:183]
    s_lshr_b32 s61, s61, 1
    v_mfma_f32_16x16x32_bf16 v[184:187], a[56:59], v[60:63], v[184:187]
    s_mul_i32 s59, s48, 1572864
    v_mfma_f32_16x16x32_bf16 v[188:191], a[60:63], v[60:63], v[188:191]
    s_waitcnt vmcnt(8)
    v_mfma_f32_16x16x32_bf16 v[176:179], a[64:67], v[64:67], v[176:179]
    buffer_load_dwordx4 v[60:63], v16, s[16:19], s45 offen sc1
    v_mfma_f32_16x16x32_bf16 v[180:183], a[68:71], v[64:67], v[180:183]
    s_lshl_b32 s5, s52, 7
    v_mfma_f32_16x16x32_bf16 v[184:187], a[72:75], v[64:67], v[184:187]
    s_add_u32 s59, s59, s5
    v_mfma_f32_16x16x32_bf16 v[188:191], a[76:79], v[64:67], v[188:191]
    s_waitcnt vmcnt(8)
    v_mfma_f32_16x16x32_bf16 v[176:179], a[80:83], v[68:71], v[176:179]
    buffer_load_dwordx4 v[64:67], v16, s[16:19], s46 offen sc1
    v_mfma_f32_16x16x32_bf16 v[180:183], a[84:87], v[68:71], v[180:183]
    s_add_u32 s60, s59, 1572864
    v_mfma_f32_16x16x32_bf16 v[184:187], a[88:91], v[68:71], v[184:187]
    s_lshl_b32 s58, s61, 17
    v_mfma_f32_16x16x32_bf16 v[188:191], a[92:95], v[68:71], v[188:191]
    s_waitcnt vmcnt(8)
    v_mfma_f32_16x16x32_bf16 v[176:179], a[96:99], v[72:75], v[176:179]
    buffer_load_dwordx4 v[68:71], v16, s[16:19], s47 offen sc1
    v_mfma_f32_16x16x32_bf16 v[180:183], a[100:103], v[72:75], v[180:183]
    s_add_u32 s58, s58, s59
    v_mfma_f32_16x16x32_bf16 v[184:187], a[104:107], v[72:75], v[184:187]
    v_mfma_f32_16x16x32_bf16 v[188:191], a[108:111], v[72:75], v[188:191]
    s_waitcnt vmcnt(8)
    v_mfma_f32_16x16x32_bf16 v[176:179], a[112:115], v[76:79], v[176:179]
    buffer_load_dwordx4 v[72:75], v15, s[16:19], s32 offen sc1
    v_mfma_f32_16x16x32_bf16 v[180:183], a[116:119], v[76:79], v[180:183]
    s_mul_i32 s4, s51, -3072
    v_mfma_f32_16x16x32_bf16 v[184:187], a[120:123], v[76:79], v[184:187]
    s_add_u32 s4, s4, 32768
    v_mfma_f32_16x16x32_bf16 v[188:191], a[124:127], v[76:79], v[188:191]
    s_waitcnt vmcnt(8)
    v_mfma_f32_16x16x32_bf16 v[176:179], a[128:131], v[80:83], v[176:179]
    buffer_load_dwordx4 v[76:79], v15, s[16:19], s33 offen sc1
    v_mfma_f32_16x16x32_bf16 v[180:183], a[132:135], v[80:83], v[180:183]
    v_add_u32 v17, s4, v47
    v_mfma_f32_16x16x32_bf16 v[184:187], a[136:139], v[80:83], v[184:187]
    v_min_u32 v167, 29, v0
    v_mfma_f32_16x16x32_bf16 v[188:191], a[140:143], v[80:83], v[188:191]
    s_waitcnt vmcnt(8)
    v_mfma_f32_16x16x32_bf16 v[176:179], a[144:147], v[84:87], v[176:179]
    buffer_load_dwordx4 v[80:83], v15, s[16:19], s34 offen sc1
    v_mfma_f32_16x16x32_bf16 v[180:183], a[148:151], v[84:87], v[180:183]
    v_mul_u32_u24 v168, 43, v167
    v_mfma_f32_16x16x32_bf16 v[184:187], a[152:155], v[84:87], v[184:187]
    v_lshrrev_b32 v168, 8, v168
    v_mfma_f32_16x16x32_bf16 v[188:191], a[156:159], v[84:87], v[188:191]
    s_waitcnt vmcnt(8)
    v_mfma_f32_16x16x32_bf16 v[176:179], a[160:163], v[48:51], v[176:179]
    buffer_load_dwordx4 v[84:87], v15, s[16:19], s35 offen sc1
    v_mfma_f32_16x16x32_bf16 v[180:183], a[164:167], v[48:51], v[180:183]
    v_lshrrev_b32 v19, 2, v168
    v_mfma_f32_16x16x32_bf16 v[184:187], a[168:171], v[48:51], v[184:187]
    v_mul_u32_u24 v168, 18, v168
    v_mfma_f32_16x16x32_bf16 v[188:191], a[172:175], v[48:51], v[188:191]
    s_waitcnt vmcnt(8)
    v_mfma_f32_16x16x32_bf16 v[176:179], a[176:179], v[52:55], v[176:179]
    buffer_load_dwordx4 v[48:51], v15, s[16:19], s36 offen sc1
    v_mfma_f32_16x16x32_bf16 v[180:183], a[180:183], v[52:55], v[180:183]
    v_add_u32 v167, v167, v168
    v_mfma_f32_16x16x32_bf16 v[184:187], a[184:187], v[52:55], v[184:187]
    s_mul_i32 s4, s51, -72
    v_mfma_f32_16x16x32_bf16 v[188:191], a[188:191], v[52:55], v[188:191]
    s_waitcnt vmcnt(8)
    v_mfma_f32_16x16x32_bf16 v[176:179], a[192:195], v[56:59], v[176:179]
    buffer_load_dwordx4 v[52:55], v15, s[16:19], s37 offen sc1
    v_mfma_f32_16x16x32_bf16 v[180:183], a[196:199], v[56:59], v[180:183]
    s_add_u32 s4, s4, 672
    v_mfma_f32_16x16x32_bf16 v[184:187], a[200:203], v[56:59], v[184:187]
    v_mad_u32_u24 v167, v19, s4, v167
    v_mfma_f32_16x16x32_bf16 v[188:191], a[204:207], v[56:59], v[188:191]
    s_waitcnt vmcnt(8)
    v_mfma_f32_16x16x32_bf16 v[176:179], a[208:211], v[60:63], v[176:179]
    buffer_load_dwordx4 v[56:59], v15, s[16:19], s38 offen sc1
    v_mfma_f32_16x16x32_bf16 v[180:183], a[212:215], v[60:63], v[180:183]
    s_mul_i32 s4, s51, 96
    v_mfma_f32_16x16x32_bf16 v[184:187], a[216:219], v[60:63], v[184:187]
    s_mul_i32 s5, s48, 6
    v_mfma_f32_16x16x32_bf16 v[188:191], a[220:223], v[60:63], v[188:191]
    s_waitcnt vmcnt(8)
    v_mfma_f32_16x16x32_bf16 v[176:179], a[224:227], v[64:67], v[176:179]
    buffer_load_dwordx4 v[60:63], v15, s[16:19], s39 offen sc1
    v_mfma_f32_16x16x32_bf16 v[180:183], a[228:231], v[64:67], v[180:183]
    s_add_u32 s4, s4, s5
    v_mfma_f32_16x16x32_bf16 v[184:187], a[232:235], v[64:67], v[184:187]
    s_lshl_b32 s4, s4, 6
    v_mfma_f32_16x16x32_bf16 v[188:191], a[236:239], v[64:67], v[188:191]
    s_waitcnt vmcnt(8)
    v_mfma_f32_16x16x32_bf16 v[176:179], a[240:243], v[68:71], v[176:179]
    buffer_load_dwordx4 v[64:67], v15, s[16:19], s40 offen sc1
    v_mfma_f32_16x16x32_bf16 v[180:183], a[244:247], v[68:71], v[180:183]
    s_add_u32 s4, s4, 4784128
    v_mfma_f32_16x16x32_bf16 v[184:187], a[248:251], v[68:71], v[184:187]
    v_lshl_add_u32 v19, v167, 6, s4
    v_mfma_f32_16x16x32_bf16 v[188:191], a[252:255], v[68:71], v[188:191]
    s_waitcnt vmcnt(8)
    v_mfma_f32_16x16x32_bf16 v[192:195], a[0:3], v[72:75], 0
    buffer_load_dwordx4 v[68:71], v15, s[16:19], s41 offen sc1
    v_mfma_f32_16x16x32_bf16 v[196:199], a[4:7], v[72:75], 0
    v_mfma_f32_16x16x32_bf16 v[200:203], a[8:11], v[72:75], 0
    v_mfma_f32_16x16x32_bf16 v[204:207], a[12:15], v[72:75], 0
    s_waitcnt vmcnt(8)
    v_mfma_f32_16x16x32_bf16 v[192:195], a[16:19], v[76:79], v[192:195]
    buffer_load_dwordx4 v[72:75], v15, s[16:19], s42 offen sc1
    v_mfma_f32_16x16x32_bf16 v[196:199], a[20:23], v[76:79], v[196:199]
    v_mfma_f32_16x16x32_bf16 v[200:203], a[24:27], v[76:79], v[200:203]
    v_mfma_f32_16x16x32_bf16 v[204:207], a[28:31], v[76:79], v[204:207]
    s_waitcnt vmcnt(8)
    v_mfma_f32_16x16x32_bf16 v[192:195], a[32:35], v[80:83], v[192:195]
    buffer_load_dwordx4 v[76:79], v15, s[16:19], s43 offen sc1
    v_mfma_f32_16x16x32_bf16 v[196:199], a[36:39], v[80:83], v[196:199]
    ds_write_b128 v25, v[176:179] offset:4096
    v_mfma_f32_16x16x32_bf16 v[200:203], a[40:43], v[80:83], v[200:203]
    v_mfma_f32_16x16x32_bf16 v[204:207], a[44:47], v[80:83], v[204:207]
    s_waitcnt vmcnt(8)
    v_mfma_f32_16x16x32_bf16 v[192:195], a[48:51], v[84:87], v[192:195]
    buffer_load_dwordx4 v[80:83], v15, s[16:19], s44 offen sc1
    v_mfma_f32_16x16x32_bf16 v[196:199], a[52:55], v[84:87], v[196:199]
    ds_write_b128 v25, v[180:183] offset:5120
    v_mfma_f32_16x16x32_bf16 v[200:203], a[56:59], v[84:87], v[200:203]
    v_mfma_f32_16x16x32_bf16 v[204:207], a[60:63], v[84:87], v[204:207]
    s_waitcnt vmcnt(8)
    v_mfma_f32_16x16x32_bf16 v[192:195], a[64:67], v[48:51], v[192:195]
    buffer_load_dwordx4 v[84:87], v15, s[16:19], s45 offen sc1
    v_mfma_f32_16x16x32_bf16 v[196:199], a[68:71], v[48:51], v[196:199]
    ds_write_b128 v25, v[184:187] offset:6144
    v_mfma_f32_16x16x32_bf16 v[200:203], a[72:75], v[48:51], v[200:203]
    s_mul_i32 s4, s48, 491520
    v_mfma_f32_16x16x32_bf16 v[204:207], a[76:79], v[48:51], v[204:207]
    s_lshl_b32 s5, s51, 12
    s_waitcnt vmcnt(8)
    v_mfma_f32_16x16x32_bf16 v[192:195], a[80:83], v[52:55], v[192:195]
    buffer_load_dwordx4 v[48:51], v15, s[16:19], s46 offen sc1
    v_mfma_f32_16x16x32_bf16 v[196:199], a[84:87], v[52:55], v[196:199]
    ds_write_b128 v25, v[188:191] offset:7168
    v_mfma_f32_16x16x32_bf16 v[200:203], a[88:91], v[52:55], v[200:203]
    s_add_u32 s4, s4, s5
    v_mfma_f32_16x16x32_bf16 v[204:207], a[92:95], v[52:55], v[204:207]
    s_add_u32 s4, s4, 2621440
    s_waitcnt vmcnt(8)
    v_mfma_f32_16x16x32_bf16 v[192:195], a[96:99], v[56:59], v[192:195]
    buffer_load_dwordx4 v[52:55], v15, s[16:19], s47 offen sc1
    v_mfma_f32_16x16x32_bf16 v[196:199], a[100:103], v[56:59], v[196:199]
    v_mfma_f32_16x16x32_bf16 v[200:203], a[104:107], v[56:59], v[200:203]
    v_mfma_f32_16x16x32_bf16 v[204:207], a[108:111], v[56:59], v[204:207]
    s_waitcnt vmcnt(8)
    v_mfma_f32_16x16x32_bf16 v[192:195], a[112:115], v[60:63], v[192:195]
    buffer_load_dwordx4 v[56:59], v14, s[16:19], s32 offen sc1
    v_mfma_f32_16x16x32_bf16 v[196:199], a[116:119], v[60:63], v[196:199]
    v_mov_b32 v30, 0xbdd2d3e8
    v_mfma_f32_16x16x32_bf16 v[200:203], a[120:123], v[60:63], v[200:203]
    v_mov_b32 v31, 0xc0135761
    v_mfma_f32_16x16x32_bf16 v[204:207], a[124:127], v[60:63], v[204:207]
    s_waitcnt vmcnt(8)
    v_mfma_f32_16x16x32_bf16 v[192:195], a[128:131], v[64:67], v[192:195]
    buffer_load_dwordx4 v[60:63], v14, s[16:19], s33 offen sc1
    v_mfma_f32_16x16x32_bf16 v[196:199], a[132:135], v[64:67], v[196:199]
    s_lshl2_add_u32 s98, s49, s53
    v_mfma_f32_16x16x32_bf16 v[200:203], a[136:139], v[64:67], v[200:203]
    s_mul_i32 s96, s50, 81920
    v_mfma_f32_16x16x32_bf16 v[204:207], a[140:143], v[64:67], v[204:207]
    s_waitcnt vmcnt(8)
    v_mfma_f32_16x16x32_bf16 v[192:195], a[144:147], v[68:71], v[192:195]
    buffer_load_dwordx4 v[64:67], v14, s[16:19], s34 offen sc1
    v_mfma_f32_16x16x32_bf16 v[196:199], a[148:151], v[68:71], v[196:199]
    s_lshl_b32 s97, s98, 10
    v_mfma_f32_16x16x32_bf16 v[200:203], a[152:155], v[68:71], v[200:203]
    s_add_u32 s96, s96, s97
    v_mfma_f32_16x16x32_bf16 v[204:207], a[156:159], v[68:71], v[204:207]
    s_waitcnt vmcnt(8)
    v_mfma_f32_16x16x32_bf16 v[192:195], a[160:163], v[72:75], v[192:195]
    buffer_load_dwordx4 v[68:71], v14, s[16:19], s35 offen sc1
    v_mfma_f32_16x16x32_bf16 v[196:199], a[164:167], v[72:75], v[196:199]
    s_add_u32 s96, s96, 2621440
    v_mfma_f32_16x16x32_bf16 v[200:203], a[168:171], v[72:75], v[200:203]
    s_add_u32 s97, s96, 40960
    v_mfma_f32_16x16x32_bf16 v[204:207], a[172:175], v[72:75], v[204:207]
    s_waitcnt vmcnt(8)
    v_mfma_f32_16x16x32_bf16 v[192:195], a[176:179], v[76:79], v[192:195]
    buffer_load_dwordx4 v[72:75], v14, s[16:19], s36 offen sc1
    v_mfma_f32_16x16x32_bf16 v[196:199], a[180:183], v[76:79], v[196:199]
    s_mul_i32 s98, s98, 24
    v_mfma_f32_16x16x32_bf16 v[200:203], a[184:187], v[76:79], v[200:203]
    s_add_u32 s98, s98, s50
    v_mfma_f32_16x16x32_bf16 v[204:207], a[188:191], v[76:79], v[204:207]
    s_waitcnt vmcnt(8)
    v_mfma_f32_16x16x32_bf16 v[192:195], a[192:195], v[80:83], v[192:195]
    buffer_load_dwordx4 v[76:79], v14, s[16:19], s37 offen sc1
    v_mfma_f32_16x16x32_bf16 v[196:199], a[196:199], v[80:83], v[196:199]
    s_lshl_b32 s98, s98, 6
    v_mfma_f32_16x16x32_bf16 v[200:203], a[200:203], v[80:83], v[200:203]
    s_add_u32 s98, s98, 4784128
    v_mfma_f32_16x16x32_bf16 v[204:207], a[204:207], v[80:83], v[204:207]
    s_waitcnt vmcnt(8)
    v_mfma_f32_16x16x32_bf16 v[192:195], a[208:211], v[84:87], v[192:195]
    buffer_load_dwordx4 v[80:83], v14, s[16:19], s38 offen sc1
    v_mfma_f32_16x16x32_bf16 v[196:199], a[212:215], v[84:87], v[196:199]
    v_mov_b32 v24, v47
    v_mfma_f32_16x16x32_bf16 v[200:203], a[216:219], v[84:87], v[200:203]
    s_mov_b32 s63, 0
    v_mfma_f32_16x16x32_bf16 v[204:207], a[220:223], v[84:87], v[204:207]
    s_waitcnt vmcnt(8)
    v_mfma_f32_16x16x32_bf16 v[192:195], a[224:227], v[48:51], v[192:195]
    buffer_load_dwordx4 v[84:87], v14, s[16:19], s39 offen sc1
    v_mfma_f32_16x16x32_bf16 v[196:199], a[228:231], v[48:51], v[196:199]
    s_buffer_atomic_or s63, s[16:19], s98
    v_mfma_f32_16x16x32_bf16 v[200:203], a[232:235], v[48:51], v[200:203]
    v_mfma_f32_16x16x32_bf16 v[204:207], a[236:239], v[48:51], v[204:207]
    s_waitcnt vmcnt(8)
    v_mfma_f32_16x16x32_bf16 v[192:195], a[240:243], v[52:55], v[192:195]
    buffer_load_dwordx4 v[48:51], v14, s[16:19], s40 offen sc1
    v_mfma_f32_16x16x32_bf16 v[196:199], a[244:247], v[52:55], v[196:199]
    v_mfma_f32_16x16x32_bf16 v[200:203], a[248:251], v[52:55], v[200:203]
    v_mfma_f32_16x16x32_bf16 v[204:207], a[252:255], v[52:55], v[204:207]
    s_waitcnt vmcnt(8)
    v_mfma_f32_16x16x32_bf16 v[208:211], a[0:3], v[56:59], 0
    buffer_load_dwordx4 v[52:55], v14, s[16:19], s41 offen sc1
    v_mfma_f32_16x16x32_bf16 v[212:215], a[4:7], v[56:59], 0
    v_mfma_f32_16x16x32_bf16 v[216:219], a[8:11], v[56:59], 0
    v_mfma_f32_16x16x32_bf16 v[220:223], a[12:15], v[56:59], 0
    s_waitcnt vmcnt(8)
    v_mfma_f32_16x16x32_bf16 v[208:211], a[16:19], v[60:63], v[208:211]
    buffer_load_dwordx4 v[56:59], v14, s[16:19], s42 offen sc1
    v_mfma_f32_16x16x32_bf16 v[212:215], a[20:23], v[60:63], v[212:215]
    v_mfma_f32_16x16x32_bf16 v[216:219], a[24:27], v[60:63], v[216:219]
    v_mfma_f32_16x16x32_bf16 v[220:223], a[28:31], v[60:63], v[220:223]
    s_waitcnt vmcnt(8)
    v_mfma_f32_16x16x32_bf16 v[208:211], a[32:35], v[64:67], v[208:211]
    buffer_load_dwordx4 v[60:63], v14, s[16:19], s43 offen sc1
    v_mfma_f32_16x16x32_bf16 v[212:215], a[36:39], v[64:67], v[212:215]
    ds_write_b128 v25, v[192:195] offset:8192
    v_mfma_f32_16x16x32_bf16 v[216:219], a[40:43], v[64:67], v[216:219]
    v_mfma_f32_16x16x32_bf16 v[220:223], a[44:47], v[64:67], v[220:223]
    s_waitcnt vmcnt(8)
    v_mfma_f32_16x16x32_bf16 v[208:211], a[48:51], v[68:71], v[208:211]
    buffer_load_dwordx4 v[64:67], v14, s[16:19], s44 offen sc1
    v_mfma_f32_16x16x32_bf16 v[212:215], a[52:55], v[68:71], v[212:215]
    ds_write_b128 v25, v[196:199] offset:9216
    v_mfma_f32_16x16x32_bf16 v[216:219], a[56:59], v[68:71], v[216:219]
    v_mfma_f32_16x16x32_bf16 v[220:223], a[60:63], v[68:71], v[220:223]
    s_waitcnt vmcnt(8)
    v_mfma_f32_16x16x32_bf16 v[208:211], a[64:67], v[72:75], v[208:211]
    buffer_load_dwordx4 v[68:71], v14, s[16:19], s45 offen sc1
    v_mfma_f32_16x16x32_bf16 v[212:215], a[68:71], v[72:75], v[212:215]
    ds_write_b128 v25, v[200:203] offset:10240
    v_mfma_f32_16x16x32_bf16 v[216:219], a[72:75], v[72:75], v[216:219]
    v_mfma_f32_16x16x32_bf16 v[220:223], a[76:79], v[72:75], v[220:223]
    s_waitcnt vmcnt(8)
    v_mfma_f32_16x16x32_bf16 v[208:211], a[80:83], v[76:79], v[208:211]
    buffer_load_dwordx4 v[72:75], v14, s[16:19], s46 offen sc1
    v_mfma_f32_16x16x32_bf16 v[212:215], a[84:87], v[76:79], v[212:215]
    ds_write_b128 v25, v[204:207] offset:11264
    v_mfma_f32_16x16x32_bf16 v[216:219], a[88:91], v[76:79], v[216:219]
    v_mfma_f32_16x16x32_bf16 v[220:223], a[92:95], v[76:79], v[220:223]
    s_waitcnt vmcnt(8)
    v_mfma_f32_16x16x32_bf16 v[208:211], a[96:99], v[80:83], v[208:211]
    buffer_load_dwordx4 v[76:79], v14, s[16:19], s47 offen sc1
    v_mfma_f32_16x16x32_bf16 v[212:215], a[100:103], v[80:83], v[212:215]
    v_mfma_f32_16x16x32_bf16 v[216:219], a[104:107], v[80:83], v[216:219]
    v_mfma_f32_16x16x32_bf16 v[220:223], a[108:111], v[80:83], v[220:223]
    s_waitcnt vmcnt(8)
    v_mfma_f32_16x16x32_bf16 v[208:211], a[112:115], v[84:87], v[208:211]
    buffer_load_dwordx4 v[80:83], v13, s[16:19], s32 offen sc1
    v_mfma_f32_16x16x32_bf16 v[212:215], a[116:119], v[84:87], v[212:215]
    s_waitcnt lgkmcnt(0)
    s_barrier
    v_mfma_f32_16x16x32_bf16 v[216:219], a[120:123], v[84:87], v[216:219]
    s_add_u32 s5, s4, 491520
    v_mfma_f32_16x16x32_bf16 v[220:223], a[124:127], v[84:87], v[220:223]
    s_waitcnt vmcnt(8)
    v_mfma_f32_16x16x32_bf16 v[208:211], a[128:131], v[48:51], v[208:211]
    buffer_load_dwordx4 v[84:87], v13, s[16:19], s33 offen sc1
    ds_read_b128 v[224:227], v28 offset:4096
    v_mfma_f32_16x16x32_bf16 v[212:215], a[132:135], v[48:51], v[212:215]
    ds_read_b128 v[228:231], v28 offset:5120
    ds_read_b128 v[232:235], v28 offset:6144
    v_mfma_f32_16x16x32_bf16 v[216:219], a[136:139], v[48:51], v[216:219]
    ds_read_b128 v[236:239], v28 offset:7168
    s_mul_i32 s32, s61, 40960
    v_mfma_f32_16x16x32_bf16 v[220:223], a[140:143], v[48:51], v[220:223]
    s_add_u32 s32, s32, s4
    s_waitcnt vmcnt(8)
    v_mfma_f32_16x16x32_bf16 v[208:211], a[144:147], v[52:55], v[208:211]
    buffer_load_dwordx4 v[48:51], v13, s[16:19], s34 offen sc1
    ds_read_b128 v[128:131], v27 offset:8192
    v_mfma_f32_16x16x32_bf16 v[212:215], a[148:151], v[52:55], v[212:215]
    ds_read_b128 v[132:135], v27 offset:9216
    ds_read_b128 v[136:139], v27 offset:10240
    v_mfma_f32_16x16x32_bf16 v[216:219], a[152:155], v[52:55], v[216:219]
    ds_read_b128 v[140:143], v27 offset:11264
    s_add_u32 s33, s32, 40960
    s_cmp_eq_u32 s33, s5
    s_cselect_b32 s33, s4, s33
    v_mfma_f32_16x16x32_bf16 v[220:223], a[156:159], v[52:55], v[220:223]
    s_waitcnt vmcnt(8)
    v_mfma_f32_16x16x32_bf16 v[208:211], a[160:163], v[56:59], v[208:211]
    buffer_load_dwordx4 v[52:55], v13, s[16:19], s35 offen sc1
    v_mfma_f32_16x16x32_bf16 v[212:215], a[164:167], v[56:59], v[212:215]
    s_add_u32 s34, s33, 40960
    s_cmp_eq_u32 s34, s5
    s_cselect_b32 s34, s4, s34
    v_mfma_f32_16x16x32_bf16 v[216:219], a[168:171], v[56:59], v[216:219]
    v_mfma_f32_16x16x32_bf16 v[220:223], a[172:175], v[56:59], v[220:223]
    s_waitcnt vmcnt(8)
    v_mfma_f32_16x16x32_bf16 v[208:211], a[176:179], v[60:63], v[208:211]
    buffer_load_dwordx4 v[56:59], v13, s[16:19], s36 offen sc1
    s_waitcnt lgkmcnt(0)
    v_add_f32 v224, v224, v128
    v_mfma_f32_16x16x32_bf16 v[212:215], a[180:183], v[60:63], v[212:215]
    v_add_f32 v225, v225, v129
    v_add_f32 v226, v226, v130
    v_mfma_f32_16x16x32_bf16 v[216:219], a[184:187], v[60:63], v[216:219]
    v_add_f32 v227, v227, v131
    s_add_u32 s35, s34, 40960
    s_cmp_eq_u32 s35, s5
    s_cselect_b32 s35, s4, s35
    v_mfma_f32_16x16x32_bf16 v[220:223], a[188:191], v[60:63], v[220:223]
    s_waitcnt vmcnt(8)
    v_mfma_f32_16x16x32_bf16 v[208:211], a[192:195], v[64:67], v[208:211]
    buffer_load_dwordx4 v[60:63], v13, s[16:19], s37 offen sc1
    v_add_f32 v228, v228, v132
    v_mfma_f32_16x16x32_bf16 v[212:215], a[196:199], v[64:67], v[212:215]
    v_add_f32 v229, v229, v133
    v_add_f32 v230, v230, v134
    v_mfma_f32_16x16x32_bf16 v[216:219], a[200:203], v[64:67], v[216:219]
    v_add_f32 v231, v231, v135
    s_add_u32 s36, s35, 40960
    s_cmp_eq_u32 s36, s5
    s_cselect_b32 s36, s4, s36
    v_mfma_f32_16x16x32_bf16 v[220:223], a[204:207], v[64:67], v[220:223]
    s_waitcnt vmcnt(8)
    v_mfma_f32_16x16x32_bf16 v[208:211], a[208:211], v[68:71], v[208:211]
    buffer_load_dwordx4 v[64:67], v13, s[16:19], s38 offen sc1
    v_add_f32 v232, v232, v136
    v_mfma_f32_16x16x32_bf16 v[212:215], a[212:215], v[68:71], v[212:215]
    v_add_f32 v233, v233, v137
    v_add_f32 v234, v234, v138
    v_mfma_f32_16x16x32_bf16 v[216:219], a[216:219], v[68:71], v[216:219]
    v_add_f32 v235, v235, v139
    s_add_u32 s37, s36, 40960
    s_cmp_eq_u32 s37, s5
    s_cselect_b32 s37, s4, s37
    v_mfma_f32_16x16x32_bf16 v[220:223], a[220:223], v[68:71], v[220:223]
    s_waitcnt vmcnt(8)
    v_mfma_f32_16x16x32_bf16 v[208:211], a[224:227], v[72:75], v[208:211]
    buffer_load_dwordx4 v[68:71], v13, s[16:19], s39 offen sc1
    v_add_f32 v236, v236, v140
    v_mfma_f32_16x16x32_bf16 v[212:215], a[228:231], v[72:75], v[212:215]
    v_add_f32 v237, v237, v141
    v_add_f32 v238, v238, v142
    v_mfma_f32_16x16x32_bf16 v[216:219], a[232:235], v[72:75], v[216:219]
    v_add_f32 v239, v239, v143
    s_add_u32 s38, s37, 40960
    s_cmp_eq_u32 s38, s5
    s_cselect_b32 s38, s4, s38
    v_mfma_f32_16x16x32_bf16 v[220:223], a[236:239], v[72:75], v[220:223]
    s_waitcnt vmcnt(8)
    v_mfma_f32_16x16x32_bf16 v[208:211], a[240:243], v[76:79], v[208:211]
    buffer_load_dwordx4 v[72:75], v13, s[16:19], s40 offen sc1
    s_add_u32 s39, s38, 40960
    s_cmp_eq_u32 s39, s5
    s_cselect_b32 s39, s4, s39
    v_mfma_f32_16x16x32_bf16 v[212:215], a[244:247], v[76:79], v[212:215]
    v_lshlrev_b32 v192, 16, v40
    v_lshlrev_b32 v193, 16, v40
    v_mfma_f32_16x16x32_bf16 v[216:219], a[248:251], v[76:79], v[216:219]
    v_lshlrev_b32 v194, 16, v40
    v_lshlrev_b32 v195, 16, v40
    v_mfma_f32_16x16x32_bf16 v[220:223], a[252:255], v[76:79], v[220:223]
    s_or_b32 s63, s2, s48
    s_cbranch_scc1 L_noepoch
    s_mov_b32 s63, 4849664
    s_buffer_atomic_swap s7, s[16:19], s63
L_noepoch:
    s_waitcnt vmcnt(8)
    v_mfma_f32_16x16x32_bf16 v[224:227], a[0:3], v[80:83], v[224:227]
    buffer_load_dwordx4 v[76:79], v13, s[16:19], s41 offen sc1
    s_add_u32 s40, s39, 40960
    s_cmp_eq_u32 s40, s5
    s_cselect_b32 s40, s4, s40
    v_mfma_f32_16x16x32_bf16 v[228:231], a[4:7], v[80:83], v[228:231]
    v_lshlrev_b32 v196, 16, v41
    v_lshlrev_b32 v197, 16, v41
    v_mfma_f32_16x16x32_bf16 v[232:235], a[8:11], v[80:83], v[232:235]
    v_lshlrev_b32 v198, 16, v41
    v_lshlrev_b32 v199, 16, v41
    v_mfma_f32_16x16x32_bf16 v[236:239], a[12:15], v[80:83], v[236:239]
    s_waitcnt vmcnt(8)
    v_mfma_f32_16x16x32_bf16 v[224:227], a[16:19], v[84:87], v[224:227]
    buffer_load_dwordx4 v[80:83], v13, s[16:19], s42 offen sc1
    s_add_u32 s41, s40, 40960
    s_cmp_eq_u32 s41, s5
    s_cselect_b32 s41, s4, s41
    v_mfma_f32_16x16x32_bf16 v[228:231], a[20:23], v[84:87], v[228:231]
    v_lshlrev_b32 v200, 16, v42
    v_lshlrev_b32 v201, 16, v42
    v_mfma_f32_16x16x32_bf16 v[232:235], a[24:27], v[84:87], v[232:235]
    v_lshlrev_b32 v202, 16, v42
    v_lshlrev_b32 v203, 16, v42
    v_mfma_f32_16x16x32_bf16 v[236:239], a[28:31], v[84:87], v[236:239]
    s_waitcnt vmcnt(8)
    v_mfma_f32_16x16x32_bf16 v[224:227], a[32:35], v[48:51], v[224:227]
    buffer_load_dwordx4 v[84:87], v13, s[16:19], s43 offen sc1
    v_mfma_f32_16x16x32_bf16 v[228:231], a[36:39], v[48:51], v[228:231]
    ds_write_b128 v25, v[208:211] offset:12288
    v_mfma_f32_16x16x32_bf16 v[232:235], a[40:43], v[48:51], v[232:235]
    ds_write_b128 v25, v[212:215] offset:13312
    v_mfma_f32_16x16x32_bf16 v[236:239], a[44:47], v[48:51], v[236:239]
    s_add_u32 s42, s41, 40960
    s_cmp_eq_u32 s42, s5
    s_cselect_b32 s42, s4, s42
    s_waitcnt vmcnt(8)
    v_mfma_f32_16x16x32_bf16 v[224:227], a[48:51], v[52:55], v[224:227]
    buffer_load_dwordx4 v[48:51], v13, s[16:19], s44 offen sc1
    v_mfma_f32_16x16x32_bf16 v[228:231], a[52:55], v[52:55], v[228:231]
    ds_write_b128 v25, v[216:219] offset:14336
    v_mfma_f32_16x16x32_bf16 v[232:235], a[56:59], v[52:55], v[232:235]
    ds_write_b128 v25, v[220:223] offset:15360
    v_mfma_f32_16x16x32_bf16 v[236:239], a[60:63], v[52:55], v[236:239]
    s_add_u32 s43, s42, 40960
    s_cmp_eq_u32 s43, s5
    s_cselect_b32 s43, s4, s43
    s_waitcnt vmcnt(8)
    v_mfma_f32_16x16x32_bf16 v[224:227], a[64:67], v[56:59], v[224:227]
    buffer_load_dwordx4 v[52:55], v13, s[16:19], s45 offen sc1
    v_lshlrev_b32 v204, 16, v43
    v_mfma_f32_16x16x32_bf16 v[228:231], a[68:71], v[56:59], v[228:231]
    v_lshlrev_b32 v205, 16, v43
    v_lshlrev_b32 v206, 16, v43
    v_mfma_f32_16x16x32_bf16 v[232:235], a[72:75], v[56:59], v[232:235]
    v_lshlrev_b32 v207, 16, v43
    v_mfma_f32_16x16x32_bf16 v[236:239], a[76:79], v[56:59], v[236:239]
    s_waitcnt vmcnt(8)
    v_mfma_f32_16x16x32_bf16 v[224:227], a[80:83], v[60:63], v[224:227]
    buffer_load_dwordx4 v[56:59], v13, s[16:19], s46 offen sc1
    v_mul_f32 v176, 0x3e800000, v192
    v_mfma_f32_16x16x32_bf16 v[228:231], a[84:87], v[60:63], v[228:231]
    v_mul_f32 v177, 0x3e800000, v193
    v_mul_f32 v178, 0x3e800000, v194
    v_mfma_f32_16x16x32_bf16 v[232:235], a[88:91], v[60:63], v[232:235]
    v_mul_f32 v179, 0x3e800000, v195
    v_mfma_f32_16x16x32_bf16 v[236:239], a[92:95], v[60:63], v[236:239]
    s_waitcnt vmcnt(8)
    v_mfma_f32_16x16x32_bf16 v[224:227], a[96:99], v[64:67], v[224:227]
    buffer_load_dwordx4 v[60:63], v13, s[16:19], s47 offen sc1
    v_mul_f32 v180, 0x3e800000, v196
    v_mfma_f32_16x16x32_bf16 v[228:231], a[100:103], v[64:67], v[228:231]
    v_mul_f32 v181, 0x3e800000, v197
    v_mul_f32 v182, 0x3e800000, v198
    v_mfma_f32_16x16x32_bf16 v[232:235], a[104:107], v[64:67], v[232:235]
    v_mul_f32 v183, 0x3e800000, v199
    v_mfma_f32_16x16x32_bf16 v[236:239], a[108:111], v[64:67], v[236:239]
    s_waitcnt vmcnt(8)
    v_mfma_f32_16x16x32_bf16 v[224:227], a[112:115], v[68:71], v[224:227]
    s_add_u32 m0, s54, 16384
    s_nop 0
    buffer_load_dwordx4 v5, s[12:15], s58 offen offset:0 lds
    v_mul_f32 v184, 0x3e800000, v200
    v_mfma_f32_16x16x32_bf16 v[228:231], a[116:119], v[68:71], v[228:231]
    v_mul_f32 v185, 0x3e800000, v201
    v_mul_f32 v186, 0x3e800000, v202
    v_mfma_f32_16x16x32_bf16 v[232:235], a[120:123], v[68:71], v[232:235]
    v_mul_f32 v187, 0x3e800000, v203
    v_mfma_f32_16x16x32_bf16 v[236:239], a[124:127], v[68:71], v[236:239]
    s_waitcnt vmcnt(8)
    v_mfma_f32_16x16x32_bf16 v[224:227], a[128:131], v[72:75], v[224:227]
    buffer_load_dwordx4 v6, s[12:15], s58 offen offset:1024 lds
    v_mul_f32 v188, 0x3e800000, v204
    v_mfma_f32_16x16x32_bf16 v[228:231], a[132:135], v[72:75], v[228:231]
    v_mul_f32 v189, 0x3e800000, v205
    v_mul_f32 v190, 0x3e800000, v206
    v_mfma_f32_16x16x32_bf16 v[232:235], a[136:139], v[72:75], v[232:235]
    v_mul_f32 v191, 0x3e800000, v207
    v_mfma_f32_16x16x32_bf16 v[236:239], a[140:143], v[72:75], v[236:239]
    s_waitcnt vmcnt(8)
    v_mfma_f32_16x16x32_bf16 v[224:227], a[144:147], v[76:79], v[224:227]
    buffer_load_dwordx4 v7, s[12:15], s58 offen offset:2048 lds
    v_mfma_f32_16x16x32_bf16 v[228:231], a[148:151], v[76:79], v[228:231]
    v_mfma_f32_16x16x32_bf16 v[232:235], a[152:155], v[76:79], v[232:235]
    v_mfma_f32_16x16x32_bf16 v[236:239], a[156:159], v[76:79], v[236:239]
    s_waitcnt vmcnt(8)
    v_mfma_f32_16x16x32_bf16 v[224:227], a[160:163], v[80:83], v[224:227]
    buffer_load_dwordx4 v8, s[12:15], s58 offen offset:3072 lds
    s_add_u32 s58, s58, 131072
    s_cmp_eq_u32 s58, s60
    s_cselect_b32 s58, s59, s58
    v_mfma_f32_16x16x32_bf16 v[228:231], a[164:167], v[80:83], v[228:231]
    s_waitcnt lgkmcnt(0)
    s_barrier
    v_mfma_f32_16x16x32_bf16 v[232:235], a[168:171], v[80:83], v[232:235]
    v_mfma_f32_16x16x32_bf16 v[236:239], a[172:175], v[80:83], v[236:239]
    s_waitcnt vmcnt(8)
    v_mfma_f32_16x16x32_bf16 v[224:227], a[176:179], v[84:87], v[224:227]
    ds_read_b128 v[160:163], v26 offset:12288
    v_mfma_f32_16x16x32_bf16 v[228:231], a[180:183], v[84:87], v[228:231]
    ds_read_b128 v[164:167], v26 offset:13312
    v_mfma_f32_16x16x32_bf16 v[232:235], a[184:187], v[84:87], v[232:235]
    v_mfma_f32_16x16x32_bf16 v[236:239], a[188:191], v[84:87], v[236:239]
    s_waitcnt vmcnt(7)
    v_mfma_f32_16x16x32_bf16 v[224:227], a[192:195], v[48:51], v[224:227]
    ds_read_b128 v[168:171], v26 offset:14336
    v_mfma_f32_16x16x32_bf16 v[228:231], a[196:199], v[48:51], v[228:231]
    ds_read_b128 v[172:175], v26 offset:15360
    v_mfma_f32_16x16x32_bf16 v[232:235], a[200:203], v[48:51], v[232:235]
    v_mfma_f32_16x16x32_bf16 v[236:239], a[204:207], v[48:51], v[236:239]
    s_waitcnt vmcnt(6)
    v_mfma_f32_16x16x32_bf16 v[224:227], a[208:211], v[52:55], v[224:227]
    v_mfma_f32_16x16x32_bf16 v[228:231], a[212:215], v[52:55], v[228:231]
    v_mfma_f32_16x16x32_bf16 v[232:235], a[216:219], v[52:55], v[232:235]
    v_mfma_f32_16x16x32_bf16 v[236:239], a[220:223], v[52:55], v[236:239]
    s_waitcnt vmcnt(5)
    v_mfma_f32_16x16x32_bf16 v[224:227], a[224:227], v[56:59], v[224:227]
    v_mfma_f32_16x16x32_bf16 v[228:231], a[228:231], v[56:59], v[228:231]
    v_mfma_f32_16x16x32_bf16 v[232:235], a[232:235], v[56:59], v[232:235]
    v_mfma_f32_16x16x32_bf16 v[236:239], a[236:239], v[56:59], v[236:239]
    s_waitcnt vmcnt(4)
    v_mfma_f32_16x16x32_bf16 v[224:227], a[240:243], v[60:63], v[224:227]
    v_mfma_f32_16x16x32_bf16 v[228:231], a[244:247], v[60:63], v[228:231]
    v_mfma_f32_16x16x32_bf16 v[232:235], a[248:251], v[60:63], v[232:235]
    v_mfma_f32_16x16x32_bf16 v[236:239], a[252:255], v[60:63], v[236:239]
    s_waitcnt lgkmcnt(0)
    s_nop 3
    v_pk_add_f32 v[224:225], v[224:225], v[160:161]
    v_pk_add_f32 v[226:227], v[226:227], v[162:163]
    v_pk_add_f32 v[228:229], v[228:229], v[164:165]
    v_pk_add_f32 v[230:231], v[230:231], v[166:167]
    v_pk_mul_f32 v[128:129], v[224:225], v[224:225]
    v_pk_mul_f32 v[130:131], v[226:227], v[226:227]
    v_pk_mul_f32 v[132:133], v[228:229], v[228:229]
    v_pk_mul_f32 v[134:135], v[230:231], v[230:231]
    v_pk_fma_f32 v[128:129], v[128:129], v[30:31], v[30:31] op_sel:[0,0,1] op_sel_hi:[1,0,1]
    v_pk_fma_f32 v[130:131], v[130:131], v[30:31], v[30:31] op_sel:[0,0,1] op_sel_hi:[1,0,1]
    v_pk_fma_f32 v[132:133], v[132:133], v[30:31], v[30:31] op_sel:[0,0,1] op_sel_hi:[1,0,1]
    v_pk_fma_f32 v[134:135], v[134:135], v[30:31], v[30:31] op_sel:[0,0,1] op_sel_hi:[1,0,1]
    v_pk_mul_f32 v[128:129], v[128:129], v[224:225]
    v_pk_mul_f32 v[130:131], v[130:131], v[226:227]
    v_pk_mul_f32 v[132:133], v[132:133], v[228:229]
    v_pk_mul_f32 v[134:135], v[134:135], v[230:231]
    v_exp_f32 v128, v128
    v_exp_f32 v129, v129
    v_exp_f32 v130, v130
    v_exp_f32 v131, v131
    v_exp_f32 v132, v132
    v_exp_f32 v133, v133
    v_exp_f32 v134, v134
    v_exp_f32 v135, v135
    v_pk_add_f32 v[128:129], v[128:129], 1.0 op_sel_hi:[1,0]
    v_pk_add_f32 v[130:131], v[130:131], 1.0 op_sel_hi:[1,0]
    v_pk_add_f32 v[132:133], v[132:133], 1.0 op_sel_hi:[1,0]
    v_pk_add_f32 v[134:135], v[134:135], 1.0 op_sel_hi:[1,0]
    v_rcp_f32 v128, v128
    v_rcp_f32 v129, v129
    v_rcp_f32 v130, v130
    v_rcp_f32 v131, v131
    v_rcp_f32 v132, v132
    v_rcp_f32 v133, v133
    v_rcp_f32 v134, v134
    v_rcp_f32 v135, v135
    v_pk_mul_f32 v[224:225], v[224:225], v[128:129]
    v_pk_mul_f32 v[226:227], v[226:227], v[130:131]
    v_pk_mul_f32 v[228:229], v[228:229], v[132:133]
    v_pk_mul_f32 v[230:231], v[230:231], v[134:135]
    v_cvt_pk_bf16_f32 v144, v224, v225
    v_cvt_pk_bf16_f32 v145, v226, v227
    v_cvt_pk_bf16_f32 v146, v228, v229
    v_cvt_pk_bf16_f32 v147, v230, v231
    buffer_store_dwordx4 v[144:147], v24, s[16:19], s96 offen sc1
    v_pk_add_f32 v[232:233], v[232:233], v[168:169]
    v_pk_add_f32 v[234:235], v[234:235], v[170:171]
    v_pk_add_f32 v[236:237], v[236:237], v[172:173]
    v_pk_add_f32 v[238:239], v[238:239], v[174:175]
    v_pk_mul_f32 v[136:137], v[232:233], v[232:233]
    v_pk_mul_f32 v[138:139], v[234:235], v[234:235]
    v_pk_mul_f32 v[140:141], v[236:237], v[236:237]
    v_pk_mul_f32 v[142:143], v[238:239], v[238:239]
    v_pk_fma_f32 v[136:137], v[136:137], v[30:31], v[30:31] op_sel:[0,0,1] op_sel_hi:[1,0,1]
    v_pk_fma_f32 v[138:139], v[138:139], v[30:31], v[30:31] op_sel:[0,0,1] op_sel_hi:[1,0,1]
    v_pk_fma_f32 v[140:141], v[140:141], v[30:31], v[30:31] op_sel:[0,0,1] op_sel_hi:[1,0,1]
    v_pk_fma_f32 v[142:143], v[142:143], v[30:31], v[30:31] op_sel:[0,0,1] op_sel_hi:[1,0,1]
    v_pk_mul_f32 v[136:137], v[136:137], v[232:233]
    v_pk_mul_f32 v[138:139], v[138:139], v[234:235]
    v_pk_mul_f32 v[140:141], v[140:141], v[236:237]
    v_pk_mul_f32 v[142:143], v[142:143], v[238:239]
    v_exp_f32 v136, v136
    v_exp_f32 v137, v137
    v_exp_f32 v138, v138
    v_exp_f32 v139, v139
    v_exp_f32 v140, v140
    v_exp_f32 v141, v141
    v_exp_f32 v142, v142
    v_exp_f32 v143, v143
    v_pk_add_f32 v[136:137], v[136:137], 1.0 op_sel_hi:[1,0]
    v_pk_add_f32 v[138:139], v[138:139], 1.0 op_sel_hi:[1,0]
    v_pk_add_f32 v[140:141], v[140:141], 1.0 op_sel_hi:[1,0]
    v_pk_add_f32 v[142:143], v[142:143], 1.0 op_sel_hi:[1,0]
    v_rcp_f32 v136, v136
    v_rcp_f32 v137, v137
    v_rcp_f32 v138, v138
    v_rcp_f32 v139, v139
    v_rcp_f32 v140, v140
    v_rcp_f32 v141, v141
    v_rcp_f32 v142, v142
    v_rcp_f32 v143, v143
    v_pk_mul_f32 v[232:233], v[232:233], v[136:137]
    v_pk_mul_f32 v[234:235], v[234:235], v[138:139]
    v_pk_mul_f32 v[236:237], v[236:237], v[140:141]
    v_pk_mul_f32 v[238:239], v[238:239], v[142:143]
    v_cvt_pk_bf16_f32 v148, v232, v233
    v_cvt_pk_bf16_f32 v149, v234, v235
    v_cvt_pk_bf16_f32 v150, v236, v237
    v_cvt_pk_bf16_f32 v151, v238, v239
    buffer_store_dwordx4 v[148:151], v24, s[16:19], s97 offen sc1
L_join:
    s_add_u32 m0, s54, 20480
    s_nop 0
    buffer_load_dwordx4 v5, s[12:15], s58 offen offset:0 lds
    s_waitcnt vmcnt(6)
    buffer_load_dwordx4 v6, s[12:15], s58 offen offset:1024 lds
    s_waitcnt vmcnt(6)
    buffer_load_dwordx4 v7, s[12:15], s58 offen offset:2048 lds
    s_waitcnt vmcnt(6)
    buffer_load_dwordx4 v8, s[12:15], s58 offen offset:3072 lds
    s_add_u32 s58, s58, 131072
    s_cmp_eq_u32 s58, s60
    s_cselect_b32 s58, s59, s58
    s_waitcnt vmcnt(6)
    s_add_u32 m0, s54, 24576
    s_nop 0
    buffer_load_dwordx4 v5, s[12:15], s58 offen offset:0 lds
    ds_read_b64_tr_b16 a[0:1], v9 offset:16384
    ds_read_b64_tr_b16 a[2:3], v9 offset:18432
    ds_read_b64_tr_b16 a[4:5], v10 offset:16384
    ds_read_b64_tr_b16 a[6:7], v10 offset:18432
    ds_read_b64_tr_b16 a[8:9], v11 offset:16384
    ds_read_b64_tr_b16 a[10:11], v11 offset:18432
    ds_read_b64_tr_b16 a[12:13], v12 offset:16384
    ds_read_b64_tr_b16 a[14:15], v12 offset:18432
    s_waitcnt vmcnt(6)
    buffer_load_dwordx4 v6, s[12:15], s58 offen offset:1024 lds
    s_waitcnt vmcnt(6)
    s_cmp_eq_u32 s3, 0
    s_cbranch_scc1 L_noflag
    s_buffer_atomic_swap s7, s[16:19], s98
L_noflag:
    buffer_load_dwordx4 v7, s[12:15], s58 offen offset:2048 lds
    buffer_load_dwordx4 v8, s[12:15], s58 offen offset:3072 lds
    s_add_u32 s58, s58, 131072
    s_cmp_eq_u32 s58, s60
    s_cselect_b32 s58, s59, s58
    s_add_u32 m0, s54, 28672
    s_nop 0
    buffer_load_dwordx4 v5, s[12:15], s58 offen offset:0 lds
    buffer_load_dwordx4 v6, s[12:15], s58 offen offset:1024 lds
    s_waitcnt vmcnt(9)
    buffer_load_dwordx4 v7, s[12:15], s58 offen offset:2048 lds
    s_waitcnt vmcnt(9)
    buffer_load_dwordx4 v8, s[12:15], s58 offen offset:3072 lds
    s_add_u32 s58, s58, 131072
    s_cmp_eq_u32 s58, s60
    s_cselect_b32 s58, s59, s58
    s_waitcnt vmcnt(9)
    s_add_u32 m0, s54, 32768
    s_nop 0
    buffer_load_dwordx4 v5, s[12:15], s58 offen offset:0 lds
    s_waitcnt vmcnt(9)
    buffer_load_dwordx4 v6, s[12:15], s58 offen offset:1024 lds
    s_waitcnt lgkmcnt(7)
    ds_read_b64_tr_b16 a[16:17], v9 offset:20480
    ds_read_b64_tr_b16 a[18:19], v9 offset:22528
    ds_read_b64_tr_b16 a[20:21], v10 offset:20480
    ds_read_b64_tr_b16 a[22:23], v10 offset:22528
    ds_read_b64_tr_b16 a[24:25], v11 offset:20480
    ds_read_b64_tr_b16 a[26:27], v11 offset:22528
    ds_read_b64_tr_b16 a[28:29], v12 offset:20480
    ds_read_b64_tr_b16 a[30:31], v12 offset:22528
    s_waitcnt vmcnt(9)
    buffer_load_dwordx4 v7, s[12:15], s58 offen offset:2048 lds
    s_waitcnt vmcnt(9)
    buffer_load_dwordx4 v8, s[12:15], s58 offen offset:3072 lds
    s_add_u32 s58, s58, 131072
    s_cmp_eq_u32 s58, s60
    s_cselect_b32 s58, s59, s58
    s_waitcnt vmcnt(9)
    s_add_u32 m0, s54, 36864
    s_nop 0
    buffer_load_dwordx4 v5, s[12:15], s58 offen offset:0 lds
    s_waitcnt vmcnt(9)
    buffer_load_dwordx4 v6, s[12:15], s58 offen offset:1024 lds
    s_waitcnt lgkmcnt(7)
    ds_read_b64_tr_b16 a[32:33], v9 offset:24576
    ds_read_b64_tr_b16 a[34:35], v9 offset:26624
    ds_read_b64_tr_b16 a[36:37], v10 offset:24576
    ds_read_b64_tr_b16 a[38:39], v10 offset:26624
    ds_read_b64_tr_b16 a[40:41], v11 offset:24576
    ds_read_b64_tr_b16 a[42:43], v11 offset:26624
    ds_read_b64_tr_b16 a[44:45], v12 offset:24576
    ds_read_b64_tr_b16 a[46:47], v12 offset:26624
    s_waitcnt vmcnt(9)
    buffer_load_dwordx4 v7, s[12:15], s58 offen offset:2048 lds
    s_waitcnt vmcnt(9)
    buffer_load_dwordx4 v8, s[12:15], s58 offen offset:3072 lds
    s_add_u32 s58, s58, 131072
    s_cmp_eq_u32 s58, s60
    s_cselect_b32 s58, s59, s58
    s_waitcnt vmcnt(9)
    s_add_u32 m0, s54, 0
    s_nop 0
    buffer_load_dwordx4 v5, s[12:15], s58 offen offset:0 lds
    s_waitcnt vmcnt(9)
    buffer_load_dwordx4 v6, s[12:15], s58 offen offset:1024 lds
    s_waitcnt lgkmcnt(7)
    ds_read_b64_tr_b16 a[48:49], v9 offset:28672
    ds_read_b64_tr_b16 a[50:51], v9 offset:30720
    ds_read_b64_tr_b16 a[52:53], v10 offset:28672
    ds_read_b64_tr_b16 a[54:55], v10 offset:30720
    ds_read_b64_tr_b16 a[56:57], v11 offset:28672
    ds_read_b64_tr_b16 a[58:59], v11 offset:30720
    ds_read_b64_tr_b16 a[60:61], v12 offset:28672
    ds_read_b64_tr_b16 a[62:63], v12 offset:30720
    s_waitcnt vmcnt(9)
    buffer_load_dwordx4 v7, s[12:15], s58 offen offset:2048 lds
    s_waitcnt vmcnt(9)
    buffer_load_dwordx4 v8, s[12:15], s58 offen offset:3072 lds
    s_add_u32 s58, s58, 131072
    s_cmp_eq_u32 s58, s60
    s_cselect_b32 s58, s59, s58
    s_waitcnt vmcnt(9)
    s_add_u32 m0, s54, 4096
    s_nop 0
    buffer_load_dwordx4 v5, s[12:15], s58 offen offset:0 lds
    s_waitcnt vmcnt(9)
    buffer_load_dwordx4 v6, s[12:15], s58 offen offset:1024 lds
    s_waitcnt lgkmcnt(7)
    ds_read_b64_tr_b16 a[64:65], v9 offset:32768
    ds_read_b64_tr_b16 a[66:67], v9 offset:34816
    ds_read_b64_tr_b16 a[68:69], v10 offset:32768
    ds_read_b64_tr_b16 a[70:71], v10 offset:34816
    ds_read_b64_tr_b16 a[72:73], v11 offset:32768
    ds_read_b64_tr_b16 a[74:75], v11 offset:34816
    ds_read_b64_tr_b16 a[76:77], v12 offset:32768
    ds_read_b64_tr_b16 a[78:79], v12 offset:34816
    s_waitcnt vmcnt(9)
    buffer_load_dwordx4 v7, s[12:15], s58 offen offset:2048 lds
    s_waitcnt vmcnt(9)
    buffer_load_dwordx4 v8, s[12:15], s58 offen offset:3072 lds
    s_add_u32 s58, s58, 131072
    s_cmp_eq_u32 s58, s60
    s_cselect_b32 s58, s59, s58
    s_waitcnt vmcnt(9)
    s_add_u32 m0, s54, 8192
    s_nop 0
    buffer_load_dwordx4 v5, s[12:15], s58 offen offset:0 lds
    s_waitcnt vmcnt(9)
    buffer_load_dwordx4 v6, s[12:15], s58 offen offset:1024 lds
    s_waitcnt lgkmcnt(7)
    ds_read_b64_tr_b16 a[80:81], v9 offset:36864
    ds_read_b64_tr_b16 a[82:83], v9 offset:38912
    ds_read_b64_tr_b16 a[84:85], v10 offset:36864
    ds_read_b64_tr_b16 a[86:87], v10 offset:38912
    ds_read_b64_tr_b16 a[88:89], v11 offset:36864
    ds_read_b64_tr_b16 a[90:91], v11 offset:38912
    ds_read_b64_tr_b16 a[92:93], v12 offset:36864
    ds_read_b64_tr_b16 a[94:95], v12 offset:38912
    s_waitcnt vmcnt(9)
    buffer_load_dwordx4 v7, s[12:15], s58 offen offset:2048 lds
    s_waitcnt vmcnt(9)
    buffer_load_dwordx4 v8, s[12:15], s58 offen offset:3072 lds
    s_add_u32 s58, s58, 131072
    s_cmp_eq_u32 s58, s60
    s_cselect_b32 s58, s59, s58
    s_waitcnt vmcnt(9)
    s_add_u32 m0, s54, 16384
    s_nop 0
    buffer_load_dwordx4 v5, s[12:15], s58 offen offset:0 lds
    s_waitcnt vmcnt(9)
    buffer_load_dwordx4 v6, s[12:15], s58 offen offset:1024 lds
    s_waitcnt lgkmcnt(7)
    ds_read_b64_tr_b16 a[96:97], v9 offset:0
    ds_read_b64_tr_b16 a[98:99], v9 offset:2048
    ds_read_b64_tr_b16 a[100:101], v10 offset:0
    ds_read_b64_tr_b16 a[102:103], v10 offset:2048
    ds_read_b64_tr_b16 a[104:105], v11 offset:0
    ds_read_b64_tr_b16 a[106:107], v11 offset:2048
    ds_read_b64_tr_b16 a[108:109], v12 offset:0
    ds_read_b64_tr_b16 a[110:111], v12 offset:2048
    s_waitcnt vmcnt(9)
    buffer_load_dwordx4 v7, s[12:15], s58 offen offset:2048 lds
    s_waitcnt vmcnt(9)
    buffer_load_dwordx4 v8, s[12:15], s58 offen offset:3072 lds
    s_add_u32 s58, s58, 131072
    s_cmp_eq_u32 s58, s60
    s_cselect_b32 s58, s59, s58
    s_waitcnt vmcnt(9)
    s_add_u32 m0, s54, 20480
    s_nop 0
    buffer_load_dwordx4 v5, s[12:15], s58 offen offset:0 lds
    s_waitcnt vmcnt(9)
    buffer_load_dword v18, v19, s[16:19], 0 offen sc1
    s_waitcnt lgkmcnt(7)
    ds_read_b64_tr_b16 a[112:113], v9 offset:4096
    ds_read_b64_tr_b16 a[114:115], v9 offset:6144
    ds_read_b64_tr_b16 a[116:117], v10 offset:4096
    ds_read_b64_tr_b16 a[118:119], v10 offset:6144
    ds_read_b64_tr_b16 a[120:121], v11 offset:4096
    ds_read_b64_tr_b16 a[122:123], v11 offset:6144
    ds_read_b64_tr_b16 a[124:125], v12 offset:4096
    ds_read_b64_tr_b16 a[126:127], v12 offset:6144
    buffer_load_dwordx4 v6, s[12:15], s58 offen offset:1024 lds
    s_waitcnt vmcnt(10)
    buffer_load_dwordx4 v7, s[12:15], s58 offen offset:2048 lds
    s_waitcnt vmcnt(10)
    buffer_load_dwordx4 v8, s[12:15], s58 offen offset:3072 lds
    s_add_u32 s58, s58, 131072
    s_cmp_eq_u32 s58, s60
    s_cselect_b32 s58, s59, s58
    s_waitcnt vmcnt(10)
    s_add_u32 m0, s54, 24576
    s_nop 0
    buffer_load_dwordx4 v5, s[12:15], s58 offen offset:0 lds
    s_waitcnt vmcnt(10)
    buffer_load_dwordx4 v6, s[12:15], s58 offen offset:1024 lds
    s_waitcnt lgkmcnt(7)
    ds_read_b64_tr_b16 a[128:129], v9 offset:8192
    ds_read_b64_tr_b16 a[130:131], v9 offset:10240
    ds_read_b64_tr_b16 a[132:133], v10 offset:8192
    ds_read_b64_tr_b16 a[134:135], v10 offset:10240
    ds_read_b64_tr_b16 a[136:137], v11 offset:8192
    ds_read_b64_tr_b16 a[138:139], v11 offset:10240
    ds_read_b64_tr_b16 a[140:141], v12 offset:8192
    ds_read_b64_tr_b16 a[142:143], v12 offset:10240
    s_waitcnt vmcnt(10)
    buffer_load_dwordx4 v7, s[12:15], s58 offen offset:2048 lds
    s_waitcnt vmcnt(10)
    buffer_load_dwordx4 v8, s[12:15], s58 offen offset:3072 lds
    s_add_u32 s58, s58, 131072
    s_cmp_eq_u32 s58, s60
    s_cselect_b32 s58, s59, s58
    s_waitcnt vmcnt(7)
    s_waitcnt lgkmcnt(7)
    ds_read_b64_tr_b16 a[144:145], v9 offset:16384
    ds_read_b64_tr_b16 a[146:147], v9 offset:18432
    ds_read_b64_tr_b16 a[148:149], v10 offset:16384
    ds_read_b64_tr_b16 a[150:151], v10 offset:18432
    ds_read_b64_tr_b16 a[152:153], v11 offset:16384
    ds_read_b64_tr_b16 a[154:155], v11 offset:18432
    ds_read_b64_tr_b16 a[156:157], v12 offset:16384
    ds_read_b64_tr_b16 a[158:159], v12 offset:18432
    v_cmp_ne_u32 vcc, v18, v20
    s_cbranch_vccz L_p2_ok
    s_mov_b32 s6, 0
L_p2_spin:
    buffer_load_dword v18, v19, s[16:19], 0 offen sc1
    s_add_u32 s6, s6, 1
    s_cmp_ge_u32 s6, 131072
    s_waitcnt vmcnt(0)
    s_cbranch_scc1 L_p2_ok
    v_cmp_ne_u32 vcc, v18, v20
    s_cbranch_vccnz L_p2_spin
L_p2_ok:
    buffer_load_dwordx4 v[48:51], v17, s[16:19], s32 offen sc1
    buffer_load_dwordx4 v[52:55], v17, s[16:19], s33 offen sc1
    buffer_load_dwordx4 v[56:59], v17, s[16:19], s34 offen sc1
    s_waitcnt vmcnt(9)
    buffer_load_dwordx4 v[60:63], v17, s[16:19], s35 offen sc1
    s_waitcnt vmcnt(9)
    buffer_load_dwordx4 v[64:67], v17, s[16:19], s36 offen sc1
    s_waitcnt vmcnt(9)
    buffer_load_dwordx4 v[68:71], v17, s[16:19], s37 offen sc1
    s_waitcnt lgkmcnt(7)
    ds_read_b64_tr_b16 a[160:161], v9 offset:20480
    ds_read_b64_tr_b16 a[162:163], v9 offset:22528
    ds_read_b64_tr_b16 a[164:165], v10 offset:20480
    ds_read_b64_tr_b16 a[166:167], v10 offset:22528
    ds_read_b64_tr_b16 a[168:169], v11 offset:20480
    ds_read_b64_tr_b16 a[170:171], v11 offset:22528
    ds_read_b64_tr_b16 a[172:173], v12 offset:20480
    ds_read_b64_tr_b16 a[174:175], v12 offset:22528
    s_waitcnt vmcnt(9)
    buffer_load_dwordx4 v[72:75], v17, s[16:19], s38 offen sc1
    s_waitcnt vmcnt(9)
    buffer_load_dwordx4 v[76:79], v17, s[16:19], s39 offen sc1
    s_waitcnt vmcnt(9)
    buffer_load_dwordx4 v[80:83], v17, s[16:19], s40 offen sc1
    s_waitcnt vmcnt(9)
    s_waitcnt lgkmcnt(7)
    ds_read_b64_tr_b16 a[176:177], v9 offset:24576
    ds_read_b64_tr_b16 a[178:179], v9 offset:26624
    ds_read_b64_tr_b16 a[180:181], v10 offset:24576
    ds_read_b64_tr_b16 a[182:183], v10 offset:26624
    ds_read_b64_tr_b16 a[184:185], v11 offset:24576
    ds_read_b64_tr_b16 a[186:187], v11 offset:26624
    ds_read_b64_tr_b16 a[188:189], v12 offset:24576
    ds_read_b64_tr_b16 a[190:191], v12 offset:26624
    s_waitcnt lgkmcnt(0)
    s_waitcnt vmcnt(8)
    v_mfma_f32_16x16x32_bf16 v[176:179], v[48:51], a[0:3], v[176:179]
    buffer_load_dwordx4 v[84:87], v17, s[16:19], s41 offen sc1
    v_mfma_f32_16x16x32_bf16 v[180:183], v[48:51], a[4:7], v[180:183]
    v_mfma_f32_16x16x32_bf16 v[184:187], v[48:51], a[8:11], v[184:187]
    v_mfma_f32_16x16x32_bf16 v[188:191], v[48:51], a[12:15], v[188:191]
    s_waitcnt vmcnt(8)
    v_mfma_f32_16x16x32_bf16 v[176:179], v[52:55], a[16:19], v[176:179]
    buffer_load_dwordx4 v[48:51], v17, s[16:19], s42 offen sc1
    v_mfma_f32_16x16x32_bf16 v[180:183], v[52:55], a[20:23], v[180:183]
    v_and_b32 v30, 15, v0
    v_mfma_f32_16x16x32_bf16 v[184:187], v[52:55], a[24:27], v[184:187]
    v_lshrrev_b32 v31, 4, v0
    v_mfma_f32_16x16x32_bf16 v[188:191], v[52:55], a[28:31], v[188:191]
    s_waitcnt vmcnt(8)
    v_mfma_f32_16x16x32_bf16 v[176:179], v[56:59], a[32:35], v[176:179]
    buffer_load_dwordx4 v[52:55], v17, s[16:19], s43 offen sc1
    v_mfma_f32_16x16x32_bf16 v[180:183], v[56:59], a[36:39], v[180:183]
    v_mul_u32_u24 v24, 1280, v30
    v_mfma_f32_16x16x32_bf16 v[184:187], v[56:59], a[40:43], v[184:187]
    v_lshl_add_u32 v24, v31, 3, v24
    v_mfma_f32_16x16x32_bf16 v[188:191], v[56:59], a[44:47], v[188:191]
    s_waitcnt vmcnt(8)
    v_mfma_f32_16x16x32_bf16 v[176:179], v[60:63], a[48:51], v[176:179]
    buffer_load_dwordx4 v[56:59], v16, s[16:19], s32 offen sc1
    v_mfma_f32_16x16x32_bf16 v[180:183], v[60:63], a[52:55], v[180:183]
    v_mul_u32_u24 v1, 144, v30
    v_mfma_f32_16x16x32_bf16 v[184:187], v[60:63], a[56:59], v[184:187]
    v_lshl_add_u32 v1, v31, 3, v1
    v_mfma_f32_16x16x32_bf16 v[188:191], v[60:63], a[60:63], v[188:191]
    s_waitcnt vmcnt(8)
    v_mfma_f32_16x16x32_bf16 v[176:179], v[64:67], a[64:67], v[176:179]
    buffer_load_dwordx4 v[60:63], v16, s[16:19], s33 offen sc1
    v_mfma_f32_16x16x32_bf16 v[180:183], v[64:67], a[68:71], v[180:183]
    s_lshl_b32 s97, s53, 5
    v_mfma_f32_16x16x32_bf16 v[184:187], v[64:67], a[72:75], v[184:187]
    v_add_u32 v1, s97, v1
    v_mfma_f32_16x16x32_bf16 v[188:191], v[64:67], a[76:79], v[188:191]
    s_waitcnt vmcnt(8)
    v_mfma_f32_16x16x32_bf16 v[176:179], v[68:71], a[80:83], v[176:179]
    buffer_load_dwordx4 v[64:67], v16, s[16:19], s34 offen sc1
    v_mfma_f32_16x16x32_bf16 v[180:183], v[68:71], a[84:87], v[180:183]
    v_lshrrev_b32 v30, 3, v0
    v_mfma_f32_16x16x32_bf16 v[184:187], v[68:71], a[88:91], v[184:187]
    v_and_b32 v31, 7, v0
    v_mfma_f32_16x16x32_bf16 v[188:191], v[68:71], a[92:95], v[188:191]
    s_waitcnt vmcnt(8)
    v_mfma_f32_16x16x32_bf16 v[176:179], v[72:75], a[96:99], v[176:179]
    buffer_load_dwordx4 v[68:71], v16, s[16:19], s35 offen sc1
    v_mfma_f32_16x16x32_bf16 v[180:183], v[72:75], a[100:103], v[180:183]
    v_mul_u32_u24 v2, 144, v30
    v_mfma_f32_16x16x32_bf16 v[184:187], v[72:75], a[104:107], v[184:187]
    v_lshl_add_u32 v2, v31, 4, v2
    v_mfma_f32_16x16x32_bf16 v[188:191], v[72:75], a[108:111], v[188:191]
    s_waitcnt vmcnt(8)
    v_mfma_f32_16x16x32_bf16 v[176:179], v[76:79], a[112:115], v[176:179]
    buffer_load_dwordx4 v[72:75], v16, s[16:19], s36 offen sc1
    v_mfma_f32_16x16x32_bf16 v[180:183], v[76:79], a[116:119], v[180:183]
    s_mul_i32 s97, s48, 2304
    v_mfma_f32_16x16x32_bf16 v[184:187], v[76:79], a[120:123], v[184:187]
    v_add_u32 v2, s97, v2
    v_mfma_f32_16x16x32_bf16 v[188:191], v[76:79], a[124:127], v[188:191]
    s_waitcnt vmcnt(8)
    v_mfma_f32_16x16x32_bf16 v[176:179], v[80:83], a[128:131], v[176:179]
    buffer_load_dwordx4 v[76:79], v16, s[16:19], s37 offen sc1
    v_mfma_f32_16x16x32_bf16 v[180:183], v[80:83], a[132:135], v[180:183]
    v_mul_u32_u24 v3, 1280, v30
    v_mfma_f32_16x16x32_bf16 v[184:187], v[80:83], a[136:139], v[184:187]
    v_lshl_add_u32 v3, v31, 4, v3
    v_mfma_f32_16x16x32_bf16 v[188:191], v[80:83], a[140:143], v[188:191]
    s_waitcnt vmcnt(8)
    v_mfma_f32_16x16x32_bf16 v[176:179], v[84:87], a[144:147], v[176:179]
    buffer_load_dwordx4 v[80:83], v16, s[16:19], s38 offen sc1
    v_mfma_f32_16x16x32_bf16 v[180:183], v[84:87], a[148:151], v[180:183]
    s_lshl2_add_u32 s96, s52, s48
    v_mfma_f32_16x16x32_bf16 v[184:187], v[84:87], a[152:155], v[184:187]
    s_mul_i32 s96, s96, 20480
    v_mfma_f32_16x16x32_bf16 v[188:191], v[84:87], a[156:159], v[188:191]
    s_waitcnt vmcnt(8)
    v_mfma_f32_16x16x32_bf16 v[176:179], v[48:51], a[160:163], v[176:179]
    buffer_load_dwordx4 v[84:87], v16, s[16:19], s39 offen sc1
    v_mfma_f32_16x16x32_bf16 v[180:183], v[48:51], a[164:167], v[180:183]
    s_lshl_b32 s97, s51, 5
    v_mfma_f32_16x16x32_bf16 v[184:187], v[48:51], a[168:171], v[184:187]
    s_add_u32 s6, s96, s97
    v_mfma_f32_16x16x32_bf16 v[188:191], v[48:51], a[172:175], v[188:191]
    s_waitcnt vmcnt(8)
    v_mfma_f32_16x16x32_bf16 v[176:179], v[52:55], a[176:179], v[176:179]
    buffer_load_dwordx4 v[48:51], v16, s[16:19], s40 offen sc1
    v_mfma_f32_16x16x32_bf16 v[180:183], v[52:55], a[180:183], v[180:183]
    s_lshl2_add_u32 s96, s97, s96
    v_mfma_f32_16x16x32_bf16 v[184:187], v[52:55], a[184:187], v[184:187]
    s_add_u32 s97, s96, 10240
    v_mfma_f32_16x16x32_bf16 v[188:191], v[52:55], a[188:191], v[188:191]
    s_waitcnt vmcnt(8)
    v_mfma_f32_16x16x32_bf16 v[192:195], v[56:59], a[0:3], v[192:195]
    buffer_load_dwordx4 v[52:55], v16, s[16:19], s41 offen sc1
    v_mfma_f32_16x16x32_bf16 v[196:199], v[56:59], a[4:7], v[196:199]
    v_mfma_f32_16x16x32_bf16 v[200:203], v[56:59], a[8:11], v[200:203]
    v_mfma_f32_16x16x32_bf16 v[204:207], v[56:59], a[12:15], v[204:207]
    s_waitcnt vmcnt(8)
    v_mfma_f32_16x16x32_bf16 v[192:195], v[60:63], a[16:19], v[192:195]
    buffer_load_dwordx4 v[56:59], v16, s[16:19], s42 offen sc1
    v_mfma_f32_16x16x32_bf16 v[196:199], v[60:63], a[20:23], v[196:199]
    v_mfma_f32_16x16x32_bf16 v[200:203], v[60:63], a[24:27], v[200:203]
    v_mfma_f32_16x16x32_bf16 v[204:207], v[60:63], a[28:31], v[204:207]
    s_waitcnt vmcnt(8)
    v_mfma_f32_16x16x32_bf16 v[192:195], v[64:67], a[32:35], v[192:195]
    buffer_load_dwordx4 v[60:63], v16, s[16:19], s43 offen sc1
    v_mfma_f32_16x16x32_bf16 v[196:199], v[64:67], a[36:39], v[196:199]
    ds_write_b128 v25, v[176:179] offset:0
    v_mfma_f32_16x16x32_bf16 v[200:203], v[64:67], a[40:43], v[200:203]
    v_mfma_f32_16x16x32_bf16 v[204:207], v[64:67], a[44:47], v[204:207]
    s_waitcnt vmcnt(8)
    v_mfma_f32_16x16x32_bf16 v[192:195], v[68:71], a[48:51], v[192:195]
    buffer_load_dwordx4 v[64:67], v15, s[16:19], s32 offen sc1
    v_mfma_f32_16x16x32_bf16 v[196:199], v[68:71], a[52:55], v[196:199]
    ds_write_b128 v25, v[180:183] offset:1024
    v_mfma_f32_16x16x32_bf16 v[200:203], v[68:71], a[56:59], v[200:203]
    v_mfma_f32_16x16x32_bf16 v[204:207], v[68:71], a[60:63], v[204:207]
    s_waitcnt vmcnt(8)
    v_mfma_f32_16x16x32_bf16 v[192:195], v[72:75], a[64:67], v[192:195]
    buffer_load_dwordx4 v[68:71], v15, s[16:19], s33 offen sc1
    v_mfma_f32_16x16x32_bf16 v[196:199], v[72:75], a[68:71], v[196:199]
    ds_write_b128 v25, v[184:187] offset:2048
    v_mfma_f32_16x16x32_bf16 v[200:203], v[72:75], a[72:75], v[200:203]
    v_mfma_f32_16x16x32_bf16 v[204:207], v[72:75], a[76:79], v[204:207]
    s_waitcnt vmcnt(8)
    v_mfma_f32_16x16x32_bf16 v[192:195], v[76:79], a[80:83], v[192:195]
    buffer_load_dwordx4 v[72:75], v15, s[16:19], s34 offen sc1
    v_mfma_f32_16x16x32_bf16 v[196:199], v[76:79], a[84:87], v[196:199]
    ds_write_b128 v25, v[188:191] offset:3072
    v_mfma_f32_16x16x32_bf16 v[200:203], v[76:79], a[88:91], v[200:203]
    v_mfma_f32_16x16x32_bf16 v[204:207], v[76:79], a[92:95], v[204:207]
    s_waitcnt vmcnt(8)
    v_mfma_f32_16x16x32_bf16 v[192:195], v[80:83], a[96:99], v[192:195]
    buffer_load_dwordx4 v[76:79], v15, s[16:19], s35 offen sc1
    v_mfma_f32_16x16x32_bf16 v[196:199], v[80:83], a[100:103], v[196:199]
    v_mfma_f32_16x16x32_bf16 v[200:203], v[80:83], a[104:107], v[200:203]
    v_mfma_f32_16x16x32_bf16 v[204:207], v[80:83], a[108:111], v[204:207]
    s_waitcnt vmcnt(8)
    v_mfma_f32_16x16x32_bf16 v[192:195], v[84:87], a[112:115], v[192:195]
    buffer_load_dwordx4 v[80:83], v15, s[16:19], s36 offen sc1
    v_mfma_f32_16x16x32_bf16 v[196:199], v[84:87], a[116:119], v[196:199]
    v_mfma_f32_16x16x32_bf16 v[200:203], v[84:87], a[120:123], v[200:203]
    v_mfma_f32_16x16x32_bf16 v[204:207], v[84:87], a[124:127], v[204:207]
    s_waitcnt vmcnt(8)
    v_mfma_f32_16x16x32_bf16 v[192:195], v[48:51], a[128:131], v[192:195]
    buffer_load_dwordx4 v[84:87], v15, s[16:19], s37 offen sc1
    v_mfma_f32_16x16x32_bf16 v[196:199], v[48:51], a[132:135], v[196:199]
    v_mfma_f32_16x16x32_bf16 v[200:203], v[48:51], a[136:139], v[200:203]
    v_mfma_f32_16x16x32_bf16 v[204:207], v[48:51], a[140:143], v[204:207]
    s_waitcnt vmcnt(8)
    v_mfma_f32_16x16x32_bf16 v[192:195], v[52:55], a[144:147], v[192:195]
    buffer_load_dwordx4 v[48:51], v15, s[16:19], s38 offen sc1
    v_mfma_f32_16x16x32_bf16 v[196:199], v[52:55], a[148:151], v[196:199]
    v_mfma_f32_16x16x32_bf16 v[200:203], v[52:55], a[152:155], v[200:203]
    v_mfma_f32_16x16x32_bf16 v[204:207], v[52:55], a[156:159], v[204:207]
    s_waitcnt vmcnt(8)
    v_mfma_f32_16x16x32_bf16 v[192:195], v[56:59], a[160:163], v[192:195]
    buffer_load_dwordx4 v[52:55], v15, s[16:19], s39 offen sc1
    v_mfma_f32_16x16x32_bf16 v[196:199], v[56:59], a[164:167], v[196:199]
    v_mfma_f32_16x16x32_bf16 v[200:203], v[56:59], a[168:171], v[200:203]
    v_mfma_f32_16x16x32_bf16 v[204:207], v[56:59], a[172:175], v[204:207]
    s_waitcnt vmcnt(8)
    v_mfma_f32_16x16x32_bf16 v[192:195], v[60:63], a[176:179], v[192:195]
    buffer_load_dwordx4 v[56:59], v15, s[16:19], s40 offen sc1
    v_mfma_f32_16x16x32_bf16 v[196:199], v[60:63], a[180:183], v[196:199]
    v_mfma_f32_16x16x32_bf16 v[200:203], v[60:63], a[184:187], v[200:203]
    v_mfma_f32_16x16x32_bf16 v[204:207], v[60:63], a[188:191], v[204:207]
    s_waitcnt vmcnt(8)
    v_mfma_f32_16x16x32_bf16 v[208:211], v[64:67], a[0:3], 0
    buffer_load_dwordx4 v[60:63], v15, s[16:19], s41 offen sc1
    v_mfma_f32_16x16x32_bf16 v[212:215], v[64:67], a[4:7], 0
    v_mfma_f32_16x16x32_bf16 v[216:219], v[64:67], a[8:11], 0
    v_mfma_f32_16x16x32_bf16 v[220:223], v[64:67], a[12:15], 0
    s_waitcnt vmcnt(8)
    v_mfma_f32_16x16x32_bf16 v[208:211], v[68:71], a[16:19], v[208:211]
    buffer_load_dwordx4 v[64:67], v15, s[16:19], s42 offen sc1
    v_mfma_f32_16x16x32_bf16 v[212:215], v[68:71], a[20:23], v[212:215]
    v_mfma_f32_16x16x32_bf16 v[216:219], v[68:71], a[24:27], v[216:219]
    v_mfma_f32_16x16x32_bf16 v[220:223], v[68:71], a[28:31], v[220:223]
    s_waitcnt vmcnt(8)
    v_mfma_f32_16x16x32_bf16 v[208:211], v[72:75], a[32:35], v[208:211]
    buffer_load_dwordx4 v[68:71], v15, s[16:19], s43 offen sc1
    v_mfma_f32_16x16x32_bf16 v[212:215], v[72:75], a[36:39], v[212:215]
    ds_write_b128 v25, v[192:195] offset:4096
    v_mfma_f32_16x16x32_bf16 v[216:219], v[72:75], a[40:43], v[216:219]
    v_mfma_f32_16x16x32_bf16 v[220:223], v[72:75], a[44:47], v[220:223]
    s_waitcnt vmcnt(8)
    v_mfma_f32_16x16x32_bf16 v[208:211], v[76:79], a[48:51], v[208:211]
    buffer_load_dwordx4 v[72:75], v14, s[16:19], s32 offen sc1
    v_mfma_f32_16x16x32_bf16 v[212:215], v[76:79], a[52:55], v[212:215]
    ds_write_b128 v25, v[196:199] offset:5120
    v_mfma_f32_16x16x32_bf16 v[216:219], v[76:79], a[56:59], v[216:219]
    v_mfma_f32_16x16x32_bf16 v[220:223], v[76:79], a[60:63], v[220:223]
    s_waitcnt vmcnt(8)
    v_mfma_f32_16x16x32_bf16 v[208:211], v[80:83], a[64:67], v[208:211]
    buffer_load_dwordx4 v[76:79], v14, s[16:19], s33 offen sc1
    v_mfma_f32_16x16x32_bf16 v[212:215], v[80:83], a[68:71], v[212:215]
    ds_write_b128 v25, v[200:203] offset:6144
    v_mfma_f32_16x16x32_bf16 v[216:219], v[80:83], a[72:75], v[216:219]
    v_mfma_f32_16x16x32_bf16 v[220:223], v[80:83], a[76:79], v[220:223]
    s_waitcnt vmcnt(8)
    v_mfma_f32_16x16x32_bf16 v[208:211], v[84:87], a[80:83], v[208:211]
    buffer_load_dwordx4 v[80:83], v14, s[16:19], s34 offen sc1
    v_mfma_f32_16x16x32_bf16 v[212:215], v[84:87], a[84:87], v[212:215]
    ds_write_b128 v25, v[204:207] offset:7168
    v_mfma_f32_16x16x32_bf16 v[216:219], v[84:87], a[88:91], v[216:219]
    v_mfma_f32_16x16x32_bf16 v[220:223], v[84:87], a[92:95], v[220:223]
    s_waitcnt vmcnt(8)
    v_mfma_f32_16x16x32_bf16 v[208:211], v[48:51], a[96:99], v[208:211]
    buffer_load_dwordx4 v[84:87], v14, s[16:19], s35 offen sc1
    v_mfma_f32_16x16x32_bf16 v[212:215], v[48:51], a[100:103], v[212:215]
    v_mfma_f32_16x16x32_bf16 v[216:219], v[48:51], a[104:107], v[216:219]
    v_mfma_f32_16x16x32_bf16 v[220:223], v[48:51], a[108:111], v[220:223]
    s_waitcnt vmcnt(8)
    v_mfma_f32_16x16x32_bf16 v[208:211], v[52:55], a[112:115], v[208:211]
    buffer_load_dwordx4 v[48:51], v14, s[16:19], s36 offen sc1
    v_mfma_f32_16x16x32_bf16 v[212:215], v[52:55], a[116:119], v[212:215]
    v_mfma_f32_16x16x32_bf16 v[216:219], v[52:55], a[120:123], v[216:219]
    v_mfma_f32_16x16x32_bf16 v[220:223], v[52:55], a[124:127], v[220:223]
    s_waitcnt vmcnt(8)
    v_mfma_f32_16x16x32_bf16 v[208:211], v[56:59], a[128:131], v[208:211]
    buffer_load_dwordx4 v[52:55], v14, s[16:19], s37 offen sc1
    v_mfma_f32_16x16x32_bf16 v[212:215], v[56:59], a[132:135], v[212:215]
    v_mfma_f32_16x16x32_bf16 v[216:219], v[56:59], a[136:139], v[216:219]
    v_mfma_f32_16x16x32_bf16 v[220:223], v[56:59], a[140:143], v[220:223]
    s_waitcnt vmcnt(8)
    v_mfma_f32_16x16x32_bf16 v[208:211], v[60:63], a[144:147], v[208:211]
    buffer_load_dwordx4 v[56:59], v14, s[16:19], s38 offen sc1
    v_mfma_f32_16x16x32_bf16 v[212:215], v[60:63], a[148:151], v[212:215]
    v_mfma_f32_16x16x32_bf16 v[216:219], v[60:63], a[152:155], v[216:219]
    v_mfma_f32_16x16x32_bf16 v[220:223], v[60:63], a[156:159], v[220:223]
    s_waitcnt vmcnt(8)
    v_mfma_f32_16x16x32_bf16 v[208:211], v[64:67], a[160:163], v[208:211]
    buffer_load_dwordx4 v[60:63], v14, s[16:19], s39 offen sc1
    v_mfma_f32_16x16x32_bf16 v[212:215], v[64:67], a[164:167], v[212:215]
    v_mfma_f32_16x16x32_bf16 v[216:219], v[64:67], a[168:171], v[216:219]
    v_mfma_f32_16x16x32_bf16 v[220:223], v[64:67], a[172:175], v[220:223]
    s_waitcnt vmcnt(8)
    v_mfma_f32_16x16x32_bf16 v[208:211], v[68:71], a[176:179], v[208:211]
    buffer_load_dwordx4 v[64:67], v14, s[16:19], s40 offen sc1
    v_mfma_f32_16x16x32_bf16 v[212:215], v[68:71], a[180:183], v[212:215]
    v_mfma_f32_16x16x32_bf16 v[216:219], v[68:71], a[184:187], v[216:219]
    v_mfma_f32_16x16x32_bf16 v[220:223], v[68:71], a[188:191], v[220:223]
    s_waitcnt vmcnt(8)
    v_mfma_f32_16x16x32_bf16 v[224:227], v[72:75], a[0:3], 0
    buffer_load_dwordx4 v[68:71], v14, s[16:19], s41 offen sc1
    v_mfma_f32_16x16x32_bf16 v[228:231], v[72:75], a[4:7], 0
    v_mfma_f32_16x16x32_bf16 v[232:235], v[72:75], a[8:11], 0
    v_mfma_f32_16x16x32_bf16 v[236:239], v[72:75], a[12:15], 0
    s_waitcnt vmcnt(8)
    v_mfma_f32_16x16x32_bf16 v[224:227], v[76:79], a[16:19], v[224:227]
    buffer_load_dwordx4 v[72:75], v14, s[16:19], s42 offen sc1
    v_mfma_f32_16x16x32_bf16 v[228:231], v[76:79], a[20:23], v[228:231]
    v_mfma_f32_16x16x32_bf16 v[232:235], v[76:79], a[24:27], v[232:235]
    v_mfma_f32_16x16x32_bf16 v[236:239], v[76:79], a[28:31], v[236:239]
    s_waitcnt vmcnt(8)
    v_mfma_f32_16x16x32_bf16 v[224:227], v[80:83], a[32:35], v[224:227]
    buffer_load_dwordx4 v[76:79], v14, s[16:19], s43 offen sc1
    v_mfma_f32_16x16x32_bf16 v[228:231], v[80:83], a[36:39], v[228:231]
    ds_write_b128 v25, v[208:211] offset:8192
    v_mfma_f32_16x16x32_bf16 v[232:235], v[80:83], a[40:43], v[232:235]
    ds_write_b128 v25, v[212:215] offset:9216
    v_mfma_f32_16x16x32_bf16 v[236:239], v[80:83], a[44:47], v[236:239]
    s_waitcnt vmcnt(8)
    v_mfma_f32_16x16x32_bf16 v[224:227], v[84:87], a[48:51], v[224:227]
    buffer_load_dwordx4 v[80:83], v13, s[16:19], s32 offen sc1
    v_mfma_f32_16x16x32_bf16 v[228:231], v[84:87], a[52:55], v[228:231]
    ds_write_b128 v25, v[216:219] offset:10240
    v_mfma_f32_16x16x32_bf16 v[232:235], v[84:87], a[56:59], v[232:235]
    ds_write_b128 v25, v[220:223] offset:11264
    v_mfma_f32_16x16x32_bf16 v[236:239], v[84:87], a[60:63], v[236:239]
    s_waitcnt vmcnt(8)
    v_mfma_f32_16x16x32_bf16 v[224:227], v[48:51], a[64:67], v[224:227]
    buffer_load_dwordx4 v[84:87], v13, s[16:19], s33 offen sc1
    v_mfma_f32_16x16x32_bf16 v[228:231], v[48:51], a[68:71], v[228:231]
    v_mfma_f32_16x16x32_bf16 v[232:235], v[48:51], a[72:75], v[232:235]
    v_mfma_f32_16x16x32_bf16 v[236:239], v[48:51], a[76:79], v[236:239]
    s_waitcnt vmcnt(8)
    v_mfma_f32_16x16x32_bf16 v[224:227], v[52:55], a[80:83], v[224:227]
    buffer_load_dwordx4 v[48:51], v13, s[16:19], s34 offen sc1
    v_mfma_f32_16x16x32_bf16 v[228:231], v[52:55], a[84:87], v[228:231]
    s_waitcnt lgkmcnt(0)
    s_barrier
    v_mfma_f32_16x16x32_bf16 v[232:235], v[52:55], a[88:91], v[232:235]
    v_mfma_f32_16x16x32_bf16 v[236:239], v[52:55], a[92:95], v[236:239]
    s_waitcnt vmcnt(8)
    v_mfma_f32_16x16x32_bf16 v[224:227], v[56:59], a[96:99], v[224:227]
    buffer_load_dwordx4 v[52:55], v13, s[16:19], s35 offen sc1
    ds_read_b128 v[240:243], v28 offset:4096
    v_mfma_f32_16x16x32_bf16 v[228:231], v[56:59], a[100:103], v[228:231]
    ds_read_b128 v[244:247], v28 offset:5120
    ds_read_b128 v[248:251], v28 offset:6144
    v_mfma_f32_16x16x32_bf16 v[232:235], v[56:59], a[104:107], v[232:235]
    ds_read_b128 v[252:255], v28 offset:7168
    v_mfma_f32_16x16x32_bf16 v[236:239], v[56:59], a[108:111], v[236:239]
    s_waitcnt vmcnt(8)
    v_mfma_f32_16x16x32_bf16 v[224:227], v[60:63], a[112:115], v[224:227]
    buffer_load_dwordx4 v[56:59], v13, s[16:19], s36 offen sc1
    ds_read_b128 v[128:131], v27 offset:8192
    v_mfma_f32_16x16x32_bf16 v[228:231], v[60:63], a[116:119], v[228:231]
    ds_read_b128 v[132:135], v27 offset:9216
    ds_read_b128 v[136:139], v27 offset:10240
    v_mfma_f32_16x16x32_bf16 v[232:235], v[60:63], a[120:123], v[232:235]
    ds_read_b128 v[140:143], v27 offset:11264
    v_mfma_f32_16x16x32_bf16 v[236:239], v[60:63], a[124:127], v[236:239]
    s_waitcnt vmcnt(8)
    v_mfma_f32_16x16x32_bf16 v[224:227], v[64:67], a[128:131], v[224:227]
    buffer_load_dwordx4 v[60:63], v13, s[16:19], s37 offen sc1
    ds_read_b128 v[144:147], v29 offset:0
    v_mfma_f32_16x16x32_bf16 v[228:231], v[64:67], a[132:135], v[228:231]
    ds_read_b128 v[148:151], v29 offset:40960
    ds_read_b128 v[152:155], v45 offset:0
    v_mfma_f32_16x16x32_bf16 v[232:235], v[64:67], a[136:139], v[232:235]
    ds_read_b128 v[156:159], v45 offset:40960
    v_mfma_f32_16x16x32_bf16 v[236:239], v[64:67], a[140:143], v[236:239]
    s_waitcnt vmcnt(8)
    v_mfma_f32_16x16x32_bf16 v[224:227], v[68:71], a[144:147], v[224:227]
    buffer_load_dwordx4 v[64:67], v13, s[16:19], s38 offen sc1
    s_waitcnt lgkmcnt(4)
    v_add_f32 v240, v240, v128
    v_mfma_f32_16x16x32_bf16 v[228:231], v[68:71], a[148:151], v[228:231]
    v_add_f32 v241, v241, v129
    v_add_f32 v242, v242, v130
    v_mfma_f32_16x16x32_bf16 v[232:235], v[68:71], a[152:155], v[232:235]
    v_add_f32 v243, v243, v131
    v_add_f32 v244, v244, v132
    v_mfma_f32_16x16x32_bf16 v[236:239], v[68:71], a[156:159], v[236:239]
    v_add_f32 v245, v245, v133
    s_waitcnt vmcnt(8)
    v_mfma_f32_16x16x32_bf16 v[224:227], v[72:75], a[160:163], v[224:227]
    buffer_load_dwordx4 v[68:71], v13, s[16:19], s39 offen sc1
    v_add_f32 v246, v246, v134
    v_mfma_f32_16x16x32_bf16 v[228:231], v[72:75], a[164:167], v[228:231]
    v_add_f32 v247, v247, v135
    v_add_f32 v248, v248, v136
    v_mfma_f32_16x16x32_bf16 v[232:235], v[72:75], a[168:171], v[232:235]
    v_add_f32 v249, v249, v137
    v_add_f32 v250, v250, v138
    v_mfma_f32_16x16x32_bf16 v[236:239], v[72:75], a[172:175], v[236:239]
    v_add_f32 v251, v251, v139
    s_waitcnt vmcnt(8)
    v_mfma_f32_16x16x32_bf16 v[224:227], v[76:79], a[176:179], v[224:227]
    buffer_load_dwordx4 v[72:75], v13, s[16:19], s40 offen sc1
    v_add_f32 v252, v252, v140
    v_mfma_f32_16x16x32_bf16 v[228:231], v[76:79], a[180:183], v[228:231]
    v_add_f32 v253, v253, v141
    v_add_f32 v254, v254, v142
    v_mfma_f32_16x16x32_bf16 v[232:235], v[76:79], a[184:187], v[232:235]
    v_add_f32 v255, v255, v143
    s_nop 0
    v_mfma_f32_16x16x32_bf16 v[236:239], v[76:79], a[188:191], v[236:239]
    s_waitcnt vmcnt(8)
    v_mfma_f32_16x16x32_bf16 v[240:243], v[80:83], a[0:3], v[240:243]
    buffer_load_dwordx4 v[76:79], v13, s[16:19], s41 offen sc1
    s_waitcnt lgkmcnt(0)
    v_add_f32 v144, v144, v148
    v_mfma_f32_16x16x32_bf16 v[244:247], v[80:83], a[4:7], v[244:247]
    v_add_f32 v145, v145, v149
    v_add_f32 v146, v146, v150
    v_mfma_f32_16x16x32_bf16 v[248:251], v[80:83], a[8:11], v[248:251]
    v_add_f32 v147, v147, v151
    v_mfma_f32_16x16x32_bf16 v[252:255], v[80:83], a[12:15], v[252:255]
    s_waitcnt vmcnt(8)
    v_mfma_f32_16x16x32_bf16 v[240:243], v[84:87], a[16:19], v[240:243]
    buffer_load_dwordx4 v[80:83], v13, s[16:19], s42 offen sc1
    v_add_f32 v152, v152, v156
    v_mfma_f32_16x16x32_bf16 v[244:247], v[84:87], a[20:23], v[244:247]
    v_add_f32 v153, v153, v157
    v_add_f32 v154, v154, v158
    v_mfma_f32_16x16x32_bf16 v[248:251], v[84:87], a[24:27], v[248:251]
    v_add_f32 v155, v155, v159
    v_mfma_f32_16x16x32_bf16 v[252:255], v[84:87], a[28:31], v[252:255]
    s_waitcnt vmcnt(8)
    v_mfma_f32_16x16x32_bf16 v[240:243], v[48:51], a[32:35], v[240:243]
    buffer_load_dwordx4 v[84:87], v13, s[16:19], s43 offen sc1
    v_mfma_f32_16x16x32_bf16 v[244:247], v[48:51], a[36:39], v[244:247]
    ds_write_b128 v25, v[224:227] offset:12288
    v_mfma_f32_16x16x32_bf16 v[248:251], v[48:51], a[40:43], v[248:251]
    ds_write_b128 v25, v[228:231] offset:13312
    v_mfma_f32_16x16x32_bf16 v[252:255], v[48:51], a[44:47], v[252:255]
    s_waitcnt vmcnt(8)
    v_mfma_f32_16x16x32_bf16 v[240:243], v[52:55], a[48:51], v[240:243]
    ds_write_b128 v25, v[232:235] offset:14336
    v_mfma_f32_16x16x32_bf16 v[244:247], v[52:55], a[52:55], v[244:247]
    ds_write_b128 v25, v[236:239] offset:15360
    v_mfma_f32_16x16x32_bf16 v[248:251], v[52:55], a[56:59], v[248:251]
    v_mfma_f32_16x16x32_bf16 v[252:255], v[52:55], a[60:63], v[252:255]
    s_waitcnt vmcnt(7)
    v_mfma_f32_16x16x32_bf16 v[240:243], v[56:59], a[64:67], v[240:243]
    v_add_f32 v144, v144, v152
    v_mfma_f32_16x16x32_bf16 v[244:247], v[56:59], a[68:71], v[244:247]
    v_add_f32 v145, v145, v153
    v_mfma_f32_16x16x32_bf16 v[248:251], v[56:59], a[72:75], v[248:251]
    v_add_f32 v146, v146, v154
    v_mfma_f32_16x16x32_bf16 v[252:255], v[56:59], a[76:79], v[252:255]
    v_add_f32 v147, v147, v155
    s_waitcnt vmcnt(6)
    v_mfma_f32_16x16x32_bf16 v[240:243], v[60:63], a[80:83], v[240:243]
    v_cvt_pk_bf16_f32 v144, v144, v145
    v_mfma_f32_16x16x32_bf16 v[244:247], v[60:63], a[84:87], v[244:247]
    v_cvt_pk_bf16_f32 v145, v146, v147
    v_mfma_f32_16x16x32_bf16 v[248:251], v[60:63], a[88:91], v[248:251]
    v_mfma_f32_16x16x32_bf16 v[252:255], v[60:63], a[92:95], v[252:255]
    s_waitcnt vmcnt(5)
    v_mfma_f32_16x16x32_bf16 v[240:243], v[64:67], a[96:99], v[240:243]
    s_waitcnt lgkmcnt(0)
    s_barrier
    v_mfma_f32_16x16x32_bf16 v[244:247], v[64:67], a[100:103], v[244:247]
    buffer_store_dwordx2 v[144:145], v24, s[20:23], s6 offen offset:1024 sc1
    v_mfma_f32_16x16x32_bf16 v[248:251], v[64:67], a[104:107], v[248:251]
    v_mfma_f32_16x16x32_bf16 v[252:255], v[64:67], a[108:111], v[252:255]
    s_waitcnt vmcnt(5)
    v_mfma_f32_16x16x32_bf16 v[240:243], v[68:71], a[112:115], v[240:243]
    ds_read_b128 v[160:163], v26 offset:12288
    v_mfma_f32_16x16x32_bf16 v[244:247], v[68:71], a[116:119], v[244:247]
    ds_read_b128 v[164:167], v26 offset:13312
    v_mfma_f32_16x16x32_bf16 v[248:251], v[68:71], a[120:123], v[248:251]
    v_mfma_f32_16x16x32_bf16 v[252:255], v[68:71], a[124:127], v[252:255]
    s_waitcnt vmcnt(4)
    v_mfma_f32_16x16x32_bf16 v[240:243], v[72:75], a[128:131], v[240:243]
    ds_read_b128 v[168:171], v26 offset:14336
    v_mfma_f32_16x16x32_bf16 v[244:247], v[72:75], a[132:135], v[244:247]
    ds_read_b128 v[172:175], v26 offset:15360
    v_mfma_f32_16x16x32_bf16 v[248:251], v[72:75], a[136:139], v[248:251]
    v_mfma_f32_16x16x32_bf16 v[252:255], v[72:75], a[140:143], v[252:255]
    s_waitcnt vmcnt(3)
    v_mfma_f32_16x16x32_bf16 v[240:243], v[76:79], a[144:147], v[240:243]
    v_mfma_f32_16x16x32_bf16 v[244:247], v[76:79], a[148:151], v[244:247]
    v_mfma_f32_16x16x32_bf16 v[248:251], v[76:79], a[152:155], v[248:251]
    v_mfma_f32_16x16x32_bf16 v[252:255], v[76:79], a[156:159], v[252:255]
    s_waitcnt vmcnt(2)
    v_mfma_f32_16x16x32_bf16 v[240:243], v[80:83], a[160:163], v[240:243]
    v_mfma_f32_16x16x32_bf16 v[244:247], v[80:83], a[164:167], v[244:247]
    v_mfma_f32_16x16x32_bf16 v[248:251], v[80:83], a[168:171], v[248:251]
    v_mfma_f32_16x16x32_bf16 v[252:255], v[80:83], a[172:175], v[252:255]
    s_waitcnt vmcnt(1)
    v_mfma_f32_16x16x32_bf16 v[240:243], v[84:87], a[176:179], v[240:243]
    v_mfma_f32_16x16x32_bf16 v[244:247], v[84:87], a[180:183], v[244:247]
    v_mfma_f32_16x16x32_bf16 v[248:251], v[84:87], a[184:187], v[248:251]
    v_mfma_f32_16x16x32_bf16 v[252:255], v[84:87], a[188:191], v[252:255]
    s_waitcnt lgkmcnt(0)
    s_nop 3
    v_pk_add_f32 v[240:241], v[240:241], v[160:161]
    v_pk_add_f32 v[242:243], v[242:243], v[162:163]
    v_cvt_pk_bf16_f32 v128, v240, v241
    v_cvt_pk_bf16_f32 v129, v242, v243
    ds_write_b64 v1, v[128:129] offset:16384
    v_pk_add_f32 v[244:245], v[244:245], v[164:165]
    v_pk_add_f32 v[246:247], v[246:247], v[166:167]
    v_cvt_pk_bf16_f32 v130, v244, v245
    v_cvt_pk_bf16_f32 v131, v246, v247
    ds_write_b64 v1, v[130:131] offset:18688
    v_pk_add_f32 v[248:249], v[248:249], v[168:169]
    v_pk_add_f32 v[250:251], v[250:251], v[170:171]
    v_cvt_pk_bf16_f32 v132, v248, v249
    v_cvt_pk_bf16_f32 v133, v250, v251
    ds_write_b64 v1, v[132:133] offset:20992
    v_pk_add_f32 v[252:253], v[252:253], v[172:173]
    v_pk_add_f32 v[254:255], v[254:255], v[174:175]
    v_cvt_pk_bf16_f32 v134, v252, v253
    v_cvt_pk_bf16_f32 v135, v254, v255
    ds_write_b64 v1, v[134:135] offset:23296
    s_waitcnt lgkmcnt(0)
    s_barrier
    ds_read_b128 v[136:139], v2 offset:16384
    ds_read_b128 v[140:143], v2 offset:17536
    s_waitcnt lgkmcnt(1)
    buffer_store_dwordx4 v[136:139], v3, s[20:23], s96 offen sc1
    s_waitcnt lgkmcnt(0)
    buffer_store_dwordx4 v[140:143], v3, s[20:23], s97 offen sc1
L_done:
    s_endpgm
L_helper:
    s_waitcnt vmcnt(0)
    s_buffer_atomic_swap s7, s[16:19], s62
    s_barrier
    v_lshlrev_b32 v30, 3, v162
    v_lshlrev_b32 v31, 2, v163
    ds_bpermute_b32 v32, v30, v165 offset:0
    ds_bpermute_b32 v33, v30, v165 offset:4
    ds_bpermute_b32 v34, v30, v165 offset:32
    ds_bpermute_b32 v35, v30, v165 offset:36
    ds_bpermute_b32 v36, v30, v165 offset:64
    ds_bpermute_b32 v37, v30, v165 offset:68
    ds_bpermute_b32 v38, v30, v165 offset:96
    ds_bpermute_b32 v39, v30, v165 offset:100
    ds_bpermute_b32 v40, v31, v166 offset:0
    ds_bpermute_b32 v41, v31, v166 offset:64
    ds_bpermute_b32 v42, v31, v166 offset:128
    ds_bpermute_b32 v43, v31, v166 offset:192
    s_lshr_b32 s61, s51, 0
    s_mul_i32 s61, s61, 3
    s_lshr_b32 s61, s61, 1
    s_mul_i32 s59, s48, 1572864
    s_lshl_b32 s5, s52, 7
    s_add_u32 s59, s59, s5
    s_add_u32 s60, s59, 1572864
    s_lshl_b32 s58, s61, 17
    s_add_u32 s58, s58, s59
    s_mul_i32 s4, s51, -3072
    s_add_u32 s4, s4, 32768
    v_add_u32 v17, s4, v47
    v_min_u32 v167, 29, v0
    v_mul_u32_u24 v168, 43, v167
    v_lshrrev_b32 v168, 8, v168
    v_lshrrev_b32 v19, 2, v168
    v_mul_u32_u24 v168, 18, v168
    v_add_u32 v167, v167, v168
    s_mul_i32 s4, s51, -72
    s_add_u32 s4, s4, 672
    v_mad_u32_u24 v167, v19, s4, v167
    s_mul_i32 s4, s51, 96
    s_mul_i32 s5, s48, 6
    s_add_u32 s4, s4, s5
    s_lshl_b32 s4, s4, 6
    s_add_u32 s4, s4, 4784128
    v_lshl_add_u32 v19, v167, 6, s4
    s_mul_i32 s4, s48, 491520
    s_lshl_b32 s5, s51, 12
    s_add_u32 s4, s4, s5
    s_add_u32 s4, s4, 2621440
    s_add_u32 s5, s4, 491520
    s_mul_i32 s32, s61, 40960
    s_add_u32 s32, s32, s4
    s_add_u32 s33, s32, 40960
    s_cmp_eq_u32 s33, s5
    s_cselect_b32 s33, s4, s33
    s_add_u32 s34, s33, 40960
    s_cmp_eq_u32 s34, s5
    s_cselect_b32 s34, s4, s34
    s_add_u32 s35, s34, 40960
    s_cmp_eq_u32 s35, s5
    s_cselect_b32 s35, s4, s35
    s_add_u32 s36, s35, 40960
    s_cmp_eq_u32 s36, s5
    s_cselect_b32 s36, s4, s36
    s_add_u32 s37, s36, 40960
    s_cmp_eq_u32 s37, s5
    s_cselect_b32 s37, s4, s37
    s_add_u32 s38, s37, 40960
    s_cmp_eq_u32 s38, s5
    s_cselect_b32 s38, s4, s38
    s_add_u32 s39, s38, 40960
    s_cmp_eq_u32 s39, s5
    s_cselect_b32 s39, s4, s39
    s_add_u32 s40, s39, 40960
    s_cmp_eq_u32 s40, s5
    s_cselect_b32 s40, s4, s40
    s_add_u32 s41, s40, 40960
    s_cmp_eq_u32 s41, s5
    s_cselect_b32 s41, s4, s41
    s_add_u32 s42, s41, 40960
    s_cmp_eq_u32 s42, s5
    s_cselect_b32 s42, s4, s42
    s_add_u32 s43, s42, 40960
    s_cmp_eq_u32 s43, s5
    s_cselect_b32 s43, s4, s43
    s_waitcnt lgkmcnt(0)
    v_lshlrev_b32 v192, 16, v40
    v_lshlrev_b32 v193, 16, v40
    v_lshlrev_b32 v194, 16, v40
    v_lshlrev_b32 v195, 16, v40
    v_lshlrev_b32 v196, 16, v41
    v_lshlrev_b32 v197, 16, v41
    v_lshlrev_b32 v198, 16, v41
    v_lshlrev_b32 v199, 16, v41
    v_lshlrev_b32 v200, 16, v42
    v_lshlrev_b32 v201, 16, v42
    v_lshlrev_b32 v202, 16, v42
    v_lshlrev_b32 v203, 16, v42
    v_lshlrev_b32 v204, 16, v43
    v_lshlrev_b32 v205, 16, v43
    v_lshlrev_b32 v206, 16, v43
    v_lshlrev_b32 v207, 16, v43
    v_mul_f32 v176, 0x3e800000, v192
    v_mul_f32 v177, 0x3e800000, v193
    v_mul_f32 v178, 0x3e800000, v194
    v_mul_f32 v179, 0x3e800000, v195
    v_mul_f32 v180, 0x3e800000, v196
    v_mul_f32 v181, 0x3e800000, v197
    v_mul_f32 v182, 0x3e800000, v198
    v_mul_f32 v183, 0x3e800000, v199
    v_mul_f32 v184, 0x3e800000, v200
    v_mul_f32 v185, 0x3e800000, v201
    v_mul_f32 v186, 0x3e800000, v202
    v_mul_f32 v187, 0x3e800000, v203
    v_mul_f32 v188, 0x3e800000, v204
    v_mul_f32 v189, 0x3e800000, v205
    v_mul_f32 v190, 0x3e800000, v206
    v_mul_f32 v191, 0x3e800000, v207
    v_and_b32 v30, 3, v0
    v_lshlrev_b32 v30, 7, v30
    v_lshrrev_b32 v31, 2, v0
    v_lshl_add_u32 v30, v31, 12, v30
    s_and_b32 s4, s2, 7
    s_lshl_b32 s4, s4, 9
    s_mul_i32 s5, s48, 1572864
    s_add_u32 s4, s4, s5
    s_bfe_u32 s5, s2, 0x10003
    s_lshl_b32 s5, s5, 16
    s_add_u32 s4, s4, s5
    s_add_u32 s5, s4, 262144
    buffer_load_dword v164, v30, s[12:15], s5 offen sc1
    s_add_u32 s5, s4, 655360
    buffer_load_dword v164, v30, s[12:15], s5 offen sc1
    s_add_u32 s5, s4, 1048576
    buffer_load_dword v164, v30, s[12:15], s5 offen sc1
    s_add_u32 s5, s4, 1441792
    buffer_load_dword v164, v30, s[12:15], s5 offen sc1
    s_add_u32 m0, s54, 16384
    s_nop 0
    buffer_load_dwordx4 v5, s[12:15], s58 offen offset:0 lds
    buffer_load_dwordx4 v6, s[12:15], s58 offen offset:1024 lds
    buffer_load_dwordx4 v7, s[12:15], s58 offen offset:2048 lds
    buffer_load_dwordx4 v8, s[12:15], s58 offen offset:3072 lds
    s_add_u32 s58, s58, 131072
    s_cmp_eq_u32 s58, s60
    s_cselect_b32 s58, s59, s58
    v_mov_b32 v169, 4849664
    v_not_b32 v18, v20
    s_getpc_b64 s[24:25]
L_pc2:
    s_sub_u32 s24, s24, L_pc2 - L_p1_ok
    s_subb_u32 s25, s25, 0
    v_lshlrev_b32 v167, 7, v0
    v_lshl_add_u32 v167, v46, 13, v167
    v_min_u32 v167, L_helper - L_p1_ok - 4, v167
    v_cmp_ne_u32 vcc, v18, v20
    s_cbranch_vccz L_ph_ok
    s_mov_b32 s6, 0
L_ph_spin:
    global_load_dword v168, v167, s[24:25] sc1
    buffer_load_dword v18, v169, s[16:19], 0 offen sc1
    s_add_u32 s6, s6, 1
    s_cmp_ge_u32 s6, 131072
    s_waitcnt vmcnt(0)
    s_cbranch_scc1 L_ph_ok
    v_cmp_ne_u32 vcc, v18, v20
    s_cbranch_vccnz L_ph_spin
L_ph_ok:
    s_waitcnt vmcnt(0) lgkmcnt(0)
    s_branch L_join
L_end:
.section .rodata,"a"
.p2align 6
.amdhsa_kernel standalone__mixer_token_mlp__prompt_kernel
.amdhsa_next_free_vgpr 512
.amdhsa_next_free_sgpr 102
.amdhsa_accum_offset 256
.amdhsa_group_segment_fixed_size 0
.amdhsa_kernarg_size 64
.amdhsa_user_sgpr_count 2
.amdhsa_user_sgpr_kernarg_segment_ptr 1
.amdhsa_system_sgpr_workgroup_id_x 1
.amdhsa_float_denorm_mode_32 3
.end_amdhsa_kernel
```
